```python
import torch

def _softmax(x, axis=-1):
    return torch.softmax(x, dim=axis)
def _gelu(x):
    return torch.nn.functional.gelu(x, approximate="tanh")
def _silu(x):
    return torch.nn.functional.silu(x)
def _sigmoid(x):
    return torch.sigmoid(x)
def _layernorm(x, axis=-1, eps=1e-5):
    m = x.mean(dim=axis, keepdim=True)
    v = x.var(dim=axis, keepdim=True, unbiased=False)
    return (x - m) / torch.sqrt(v + eps)
def _scatter_add(tgt, idx, src, axis=0):
    return tgt.clone().index_add_(axis, idx, src)
def _segment_sum(src, seg, n):
    out = torch.zeros((n,) + src.shape[1:], dtype=src.dtype)
    return out.index_add_(0, seg, src)
def _pad(x, pw):
    flat = tuple(v for pair in reversed(pw) for v in pair)
    return torch.nn.functional.pad(x, flat)

kernel_name = 'parallel_sum__gqa_block_cached__glu_gated_reglu__decode'

def setup_inputs():

    _w = (lambda a: (lambda t: t.to(torch.bfloat16) if t.is_floating_point() else t)(torch.as_tensor(a)))
    def _A_setup():
        B, Sq, D = 8, 1, 512
        Hq, Hkv, Sk, Dh = 32, 32, 4096, 128
        assert Hq % Hkv == 0, (Hq, Hkv)
        return {
            "x": _w((lambda *s: torch.randn(*s, dtype=torch.bfloat16) * 0.05)(B, Sq, D)),
            "k_cache": _w((lambda *s: torch.randn(*s, dtype=torch.bfloat16) * 1.6)(B, Hkv, Sk, Dh)),
            "v_cache": _w((lambda *s: torch.randn(*s, dtype=torch.bfloat16) * 0.8)(B, Hkv, Sk, Dh)),
            "wq": _w((lambda *s: torch.randn(*s, dtype=torch.bfloat16) * 1.6)(D, Hq * Dh) * (D ** -0.5)),
            "wo": _w((lambda *s: torch.randn(*s, dtype=torch.bfloat16) * 0.8)(Hq * Dh, D) * ((Hq * Dh) ** -0.5)),
        }
    _A_in = _A_setup()

    def _B_setup():
        B, S, D, F = 8, 1, 512, 1376
        return {
            "x": _w((lambda *s: torch.randn(*s, dtype=torch.bfloat16) * 0.05)(B, S, D)),
            "W_gate": _w((lambda *s: torch.randn(*s, dtype=torch.bfloat16) * 0.4)(D, F) * (2.0 / D) ** 0.5),
            "W_up": _w((lambda *s: torch.randn(*s, dtype=torch.bfloat16) * 0.4)(D, F) * (2.0 / D) ** 0.5),
            "W_down": _w((lambda *s: torch.randn(*s, dtype=torch.bfloat16) * 0.4)(F, D) * (1.0 / F) ** 0.5),
        }
    _B_in = _B_setup()

    return {
        "A_x": _A_in["x"],
        "A_k_cache": _A_in["k_cache"],
        "A_v_cache": _A_in["v_cache"],
        "A_wq": _A_in["wq"],
        "A_wo": _A_in["wo"],
        "B_x": _B_in["x"],
        "B_W_gate": _B_in["W_gate"],
        "B_W_up": _B_in["W_up"],
        "B_W_down": _B_in["W_down"],
    }

def reference(A_x, A_k_cache, A_v_cache, A_wq, A_wo, B_x, B_W_gate, B_W_up, B_W_down):
    def _A_ref(x, k_cache, v_cache, wq, wo):
        B, Sq, D = x.shape
        Hq, Dh = 32, 128
        Hkv = k_cache.shape[1]
        rep = Hq // Hkv
        q = (lambda x, *d: x.permute(*d))((x @ wq).reshape(B, Sq, Hq, Dh), 0, 2, 1, 3)
        k = (lambda x, n, axis: torch.repeat_interleave(x, n, dim=axis))(k_cache, rep, axis=1)
        v = (lambda x, n, axis: torch.repeat_interleave(x, n, dim=axis))(v_cache, rep, axis=1)
        scores = torch.einsum("bhqd,bhkd->bhqk", q, k) * (Dh ** -0.5)
        p = _softmax(scores, axis=-1)
        o = torch.einsum("bhqk,bhkd->bhqd", p, v)
        return (lambda x, *d: x.permute(*d))(o, 0, 2, 1, 3).reshape(B, Sq, Hq * Dh) @ wo

    def _B_ref(x, W_gate, W_up, W_down):
        gate = torch.einsum("bsd,df->bsf", x, W_gate)
        up = torch.einsum("bsd,df->bsf", x, W_up)
        gate = gate * (lambda x, dt: x.to(dt))(gate > 0, gate.dtype)
        h = gate * up
        return torch.einsum("bsf,fd->bsd", h, W_down)

    x = A_x
    xn = _layernorm(x, axis=-1)
    return x + _A_ref(xn, A_k_cache, A_v_cache, A_wq, A_wo) + _B_ref(xn, B_W_gate, B_W_up, B_W_down)
```

```asm
; @launch grid=(256,1,1) block=(1024,1,1) lds=119808
.amdgcn_target "amdgcn-amd-amdhsa--gfx950"
.text
.globl parallel_sum__gqa_block_cached__glu_gated_reglu__decode_kernel
.p2align 8
.type parallel_sum__gqa_block_cached__glu_gated_reglu__decode_kernel,@function
parallel_sum__gqa_block_cached__glu_gated_reglu__decode_kernel:
    s_cmp_ge_u32 s2, 256
    s_cbranch_scc1 L_end
    s_load_dwordx16 s[16:31], s[0:1], 0
    s_load_dwordx8 s[32:39], s[0:1], 64
    v_and_b32 v1, 63, v0
    v_lshrrev_b32 v2, 6, v0
    s_lshr_b32 s13, s2, 5
    s_and_b32 s14, s2, 31
    v_readfirstlane_b32 s12, v2
    v_and_b32 v124, 15, v1
    v_lshrrev_b32 v125, 4, v1
    s_mov_b32 s76, 0x3fb8aa3b
    s_and_b32 s77, s14, 1
    s_waitcnt lgkmcnt(0)
    v_mov_b32 v2, 0
    ds_write_b32 v2, v2 offset:2692
    ds_write_b32 v2, v2 offset:2696
    s_waitcnt lgkmcnt(0)
    s_barrier
    s_mov_b32 s4, s18
    s_and_b32 s5, s19, 0xffff
    s_mov_b32 s6, 0x10000000
    s_mov_b32 s7, 0x00020000
    s_mov_b32 s8, s20
    s_and_b32 s9, s21, 0xffff
    s_mov_b32 s10, 0x10000000
    s_mov_b32 s11, 0x00020000
    s_lshl_b32 s15, s13, 10
    v_lshlrev_b32 v3, 4, v1
    v_add_u32 v3, s15, v3
    global_load_dwordx4 v[10:13], v3, s[16:17]
    s_lshl_b32 s15, s14, 8
    s_add_u32 s78, s22, s15
    s_addc_u32 s79, s23, 0
    s_lshl_b32 s15, s2, 20
    s_lshl_b32 s73, s12, 16
    s_add_u32 s15, s15, s73
    v_lshlrev_b32 v9, 4, v1
    v_add_u32 v9, s15, v9
    s_cmp_ge_u32 s12, 8
    s_cbranch_scc1 L_kwave0
    s_lshl_b32 s15, s12, 19
    v_lshlrev_b32 v126, 13, v125
    v_lshl_add_u32 v126, v124, 4, v126
    v_add_u32 v126, s15, v126
    global_load_dwordx4 v[76:79], v126, s[78:79]
    v_add_u32 v126, 0x8000, v126
    global_load_dwordx4 v[80:83], v126, s[78:79]
    v_add_u32 v126, 0x8000, v126
    global_load_dwordx4 v[84:87], v126, s[78:79]
    v_add_u32 v126, 0x8000, v126
    global_load_dwordx4 v[88:91], v126, s[78:79]
    v_add_u32 v126, 0x8000, v126
    global_load_dwordx4 v[92:95], v126, s[78:79]
    v_add_u32 v126, 0x8000, v126
    global_load_dwordx4 v[96:99], v126, s[78:79]
    v_add_u32 v126, 0x8000, v126
    global_load_dwordx4 v[100:103], v126, s[78:79]
    v_add_u32 v126, 0x8000, v126
    global_load_dwordx4 v[104:107], v126, s[78:79]
    v_add_u32 v126, 0x8000, v126
    global_load_dwordx4 v[108:111], v126, s[78:79]
    v_add_u32 v126, 0x8000, v126
    global_load_dwordx4 v[112:115], v126, s[78:79]
    v_add_u32 v126, 0x8000, v126
    global_load_dwordx4 v[116:119], v126, s[78:79]
    v_add_u32 v126, 0x8000, v126
    global_load_dwordx4 v[120:123], v126, s[78:79]
    v_add_u32 v126, 0x8000, v126
    global_load_dwordx4 v[28:31], v126, s[78:79]
    v_add_u32 v126, 0x8000, v126
    global_load_dwordx4 v[32:35], v126, s[78:79]
    v_add_u32 v126, 0x8000, v126
    global_load_dwordx4 v[36:39], v126, s[78:79]
    v_add_u32 v126, 0x8000, v126
    global_load_dwordx4 v[40:43], v126, s[78:79]
    s_waitcnt vmcnt(16)
    s_branch L_ln
L_kwave0:
    s_mov_b32 s72, 0
    buffer_load_dwordx4 v[76:79], v9, s[4:7], s72 offen offset:0 nt
    s_mov_b32 s72, 0
    buffer_load_dwordx4 v[80:83], v9, s[4:7], s72 offen offset:1024 nt
    s_mov_b32 s72, 0
    buffer_load_dwordx4 v[84:87], v9, s[4:7], s72 offen offset:2048 nt
    s_mov_b32 s72, 0
    buffer_load_dwordx4 v[88:91], v9, s[4:7], s72 offen offset:3072 nt
    s_mov_b32 s72, 4096
    buffer_load_dwordx4 v[92:95], v9, s[4:7], s72 offen offset:0 nt
    s_mov_b32 s72, 4096
    buffer_load_dwordx4 v[96:99], v9, s[4:7], s72 offen offset:1024 nt
    s_mov_b32 s72, 4096
    buffer_load_dwordx4 v[100:103], v9, s[4:7], s72 offen offset:2048 nt
    s_mov_b32 s72, 4096
    buffer_load_dwordx4 v[104:107], v9, s[4:7], s72 offen offset:3072 nt
    s_mov_b32 s72, 8192
    buffer_load_dwordx4 v[108:111], v9, s[4:7], s72 offen offset:0 nt
    s_mov_b32 s72, 8192
    buffer_load_dwordx4 v[112:115], v9, s[4:7], s72 offen offset:1024 nt
    s_mov_b32 s72, 8192
    buffer_load_dwordx4 v[116:119], v9, s[4:7], s72 offen offset:2048 nt
    s_mov_b32 s72, 8192
    buffer_load_dwordx4 v[120:123], v9, s[4:7], s72 offen offset:3072 nt
    s_waitcnt vmcnt(12)
L_ln:
    v_and_b32 v2, 1, v124
    v_cmp_eq_u32 vcc, 1, v2
    v_mov_b32 v3, 0xffff
    v_mov_b32 v4, 0xffff0000
    v_cndmask_b32 v3, v3, v4, vcc
    v_lshrrev_b32 v2, 1, v124
    v_cmp_eq_u32 vcc, 0, v2
    s_nop 1
    v_cndmask_b32 v20, 0, v3, vcc
    v_cmp_eq_u32 vcc, 1, v2
    s_nop 1
    v_cndmask_b32 v21, 0, v3, vcc
    v_cmp_eq_u32 vcc, 2, v2
    s_nop 1
    v_cndmask_b32 v22, 0, v3, vcc
    v_cmp_eq_u32 vcc, 3, v2
    s_nop 1
    v_cndmask_b32 v23, 0, v3, vcc
    v_lshlrev_b32 v60, 16, v10
    v_and_b32 v61, 0xffff0000, v10
    v_lshlrev_b32 v62, 16, v11
    v_and_b32 v63, 0xffff0000, v11
    v_lshlrev_b32 v64, 16, v12
    v_and_b32 v65, 0xffff0000, v12
    v_lshlrev_b32 v66, 16, v13
    v_and_b32 v67, 0xffff0000, v13
    v_add_f32 v2, v60, v61
    v_add_f32 v2, v2, v62
    v_add_f32 v2, v2, v63
    v_add_f32 v2, v2, v64
    v_add_f32 v2, v2, v65
    v_add_f32 v2, v2, v66
    v_add_f32 v2, v2, v67
    s_nop 1
    v_add_f32_dpp v2, v2, v2 row_ror:8 row_mask:0xf bank_mask:0xf
    s_nop 1
    v_add_f32_dpp v2, v2, v2 row_ror:4 row_mask:0xf bank_mask:0xf
    s_nop 1
    v_add_f32_dpp v2, v2, v2 row_ror:2 row_mask:0xf bank_mask:0xf
    s_nop 1
    v_add_f32_dpp v2, v2, v2 row_ror:1 row_mask:0xf bank_mask:0xf
    s_nop 1
    v_readlane_b32 s40, v2, 0
    v_readlane_b32 s41, v2, 16
    v_readlane_b32 s42, v2, 32
    v_readlane_b32 s43, v2, 48
    s_nop 1
    v_mov_b32 v2, s40
    v_add_f32 v2, s41, v2
    v_add_f32 v2, s42, v2
    v_add_f32 v2, s43, v2
    v_mul_f32 v2, 0x3b000000, v2
    v_sub_f32 v4, v60, v2
    v_mul_f32 v3, v4, v4
    v_sub_f32 v4, v61, v2
    v_fmac_f32 v3, v4, v4
    v_sub_f32 v4, v62, v2
    v_fmac_f32 v3, v4, v4
    v_sub_f32 v4, v63, v2
    v_fmac_f32 v3, v4, v4
    v_sub_f32 v4, v64, v2
    v_fmac_f32 v3, v4, v4
    v_sub_f32 v4, v65, v2
    v_fmac_f32 v3, v4, v4
    v_sub_f32 v4, v66, v2
    v_fmac_f32 v3, v4, v4
    v_sub_f32 v4, v67, v2
    v_fmac_f32 v3, v4, v4
    s_nop 1
    v_add_f32_dpp v3, v3, v3 row_ror:8 row_mask:0xf bank_mask:0xf
    s_nop 1
    v_add_f32_dpp v3, v3, v3 row_ror:4 row_mask:0xf bank_mask:0xf
    s_nop 1
    v_add_f32_dpp v3, v3, v3 row_ror:2 row_mask:0xf bank_mask:0xf
    s_nop 1
    v_add_f32_dpp v3, v3, v3 row_ror:1 row_mask:0xf bank_mask:0xf
    s_nop 1
    v_readlane_b32 s40, v3, 0
    v_readlane_b32 s41, v3, 16
    v_readlane_b32 s42, v3, 32
    v_readlane_b32 s43, v3, 48
    s_nop 1
    v_mov_b32 v3, s40
    v_add_f32 v3, s41, v3
    v_add_f32 v3, s42, v3
    v_add_f32 v3, s43, v3
    v_mul_f32 v3, 0x3b000000, v3
    v_cvt_pk_bf16_f32 v4, v2, v3
    v_lshlrev_b32 v2, 16, v4
    v_and_b32 v3, 0xffff0000, v4
    v_add_f32 v3, 0x3727c5ac, v3
    v_cvt_pk_bf16_f32 v3, v3, v3
    v_and_b32 v3, 0xffff0000, v3
    v_sqrt_f32 v3, v3
    s_nop 0
    v_cvt_pk_bf16_f32 v3, v3, v3
    v_and_b32 v3, 0xffff0000, v3
    v_rcp_f32 v4, v3
    s_nop 0
    v_fma_f32 v5, -v3, v4, 1.0
    v_fmac_f32 v4, v5, v4
    v_sub_f32 v60, v60, v2
    v_sub_f32 v61, v61, v2
    v_cvt_pk_bf16_f32 v5, v60, v61
    v_lshlrev_b32 v60, 16, v5
    v_and_b32 v61, 0xffff0000, v5
    v_mul_f32 v6, v60, v4
    v_mul_f32 v7, v61, v4
    v_fma_f32 v60, -v6, v3, v60
    v_fma_f32 v61, -v7, v3, v61
    v_fmac_f32 v6, v60, v4
    v_fmac_f32 v7, v61, v4
    v_cvt_pk_bf16_f32 v5, v6, v7
    v_lshlrev_b32 v60, 16, v5
    v_and_b32 v61, 0xffff0000, v5
    v_sub_f32 v62, v62, v2
    v_sub_f32 v63, v63, v2
    v_cvt_pk_bf16_f32 v5, v62, v63
    v_lshlrev_b32 v62, 16, v5
    v_and_b32 v63, 0xffff0000, v5
    v_mul_f32 v6, v62, v4
    v_mul_f32 v7, v63, v4
    v_fma_f32 v62, -v6, v3, v62
    v_fma_f32 v63, -v7, v3, v63
    v_fmac_f32 v6, v62, v4
    v_fmac_f32 v7, v63, v4
    v_cvt_pk_bf16_f32 v5, v6, v7
    v_lshlrev_b32 v62, 16, v5
    v_and_b32 v63, 0xffff0000, v5
    v_sub_f32 v64, v64, v2
    v_sub_f32 v65, v65, v2
    v_cvt_pk_bf16_f32 v5, v64, v65
    v_lshlrev_b32 v64, 16, v5
    v_and_b32 v65, 0xffff0000, v5
    v_mul_f32 v6, v64, v4
    v_mul_f32 v7, v65, v4
    v_fma_f32 v64, -v6, v3, v64
    v_fma_f32 v65, -v7, v3, v65
    v_fmac_f32 v6, v64, v4
    v_fmac_f32 v7, v65, v4
    v_cvt_pk_bf16_f32 v5, v6, v7
    v_lshlrev_b32 v64, 16, v5
    v_and_b32 v65, 0xffff0000, v5
    v_sub_f32 v66, v66, v2
    v_sub_f32 v67, v67, v2
    v_cvt_pk_bf16_f32 v5, v66, v67
    v_lshlrev_b32 v66, 16, v5
    v_and_b32 v67, 0xffff0000, v5
    v_mul_f32 v6, v66, v4
    v_mul_f32 v7, v67, v4
    v_fma_f32 v66, -v6, v3, v66
    v_fma_f32 v67, -v7, v3, v67
    v_fmac_f32 v6, v66, v4
    v_fmac_f32 v7, v67, v4
    v_cvt_pk_bf16_f32 v5, v6, v7
    v_lshlrev_b32 v66, 16, v5
    v_and_b32 v67, 0xffff0000, v5
    s_lshl_b32 s15, s12, 2
    s_add_u32 s73, s15, 0
    v_readlane_b32 s40, v60, s73
    v_readlane_b32 s41, v61, s73
    v_readlane_b32 s42, v62, s73
    v_readlane_b32 s43, v63, s73
    v_readlane_b32 s44, v64, s73
    v_readlane_b32 s45, v65, s73
    v_readlane_b32 s46, v66, s73
    v_readlane_b32 s47, v67, s73
    s_add_u32 s73, s15, 1
    v_readlane_b32 s48, v60, s73
    v_readlane_b32 s49, v61, s73
    v_readlane_b32 s50, v62, s73
    v_readlane_b32 s51, v63, s73
    v_readlane_b32 s52, v64, s73
    v_readlane_b32 s53, v65, s73
    v_readlane_b32 s54, v66, s73
    v_readlane_b32 s55, v67, s73
    s_add_u32 s73, s15, 2
    v_readlane_b32 s56, v60, s73
    v_readlane_b32 s57, v61, s73
    v_readlane_b32 s58, v62, s73
    v_readlane_b32 s59, v63, s73
    v_readlane_b32 s60, v64, s73
    v_readlane_b32 s61, v65, s73
    v_readlane_b32 s62, v66, s73
    v_readlane_b32 s63, v67, s73
    s_add_u32 s73, s15, 3
    v_readlane_b32 s64, v60, s73
    v_readlane_b32 s65, v61, s73
    v_readlane_b32 s66, v62, s73
    v_readlane_b32 s67, v63, s73
    v_readlane_b32 s68, v64, s73
    v_readlane_b32 s69, v65, s73
    v_readlane_b32 s70, v66, s73
    v_readlane_b32 s71, v67, s73
    s_cmp_ge_u32 s12, 8
    s_cbranch_scc1 L_qdone
    v_lshlrev_b32 v2, 5, v1
    ds_write_b128 v2, v[60:63] offset:0
    ds_write_b128 v2, v[64:67] offset:16
    s_waitcnt lgkmcnt(0)
    s_lshl_b32 s15, s12, 8
    v_lshlrev_b32 v2, 2, v125
    v_add_u32 v2, s15, v2
    ds_read_b32 v44, v2 offset:0
    ds_read_b32 v45, v2 offset:16
    ds_read_b32 v46, v2 offset:32
    ds_read_b32 v47, v2 offset:48
    ds_read_b32 v48, v2 offset:64
    ds_read_b32 v49, v2 offset:80
    ds_read_b32 v50, v2 offset:96
    ds_read_b32 v51, v2 offset:112
    ds_read_b32 v52, v2 offset:128
    ds_read_b32 v53, v2 offset:144
    ds_read_b32 v54, v2 offset:160
    ds_read_b32 v55, v2 offset:176
    ds_read_b32 v56, v2 offset:192
    ds_read_b32 v57, v2 offset:208
    ds_read_b32 v58, v2 offset:224
    ds_read_b32 v59, v2 offset:240
    s_waitcnt lgkmcnt(0)
    s_waitcnt vmcnt(15)
    v_lshlrev_b32 v6, 16, v76
    v_and_b32 v7, 0xffff0000, v76
    v_mul_f32 v68, v6, v44
    v_mul_f32 v69, v7, v44
    v_lshlrev_b32 v6, 16, v77
    v_and_b32 v7, 0xffff0000, v77
    v_mul_f32 v70, v6, v44
    v_mul_f32 v71, v7, v44
    v_lshlrev_b32 v6, 16, v78
    v_and_b32 v7, 0xffff0000, v78
    v_mul_f32 v72, v6, v44
    v_mul_f32 v73, v7, v44
    v_lshlrev_b32 v6, 16, v79
    v_and_b32 v7, 0xffff0000, v79
    v_mul_f32 v74, v6, v44
    v_mul_f32 v75, v7, v44
    s_waitcnt vmcnt(14)
    v_lshlrev_b32 v6, 16, v80
    v_and_b32 v7, 0xffff0000, v80
    v_fmac_f32 v68, v6, v45
    v_fmac_f32 v69, v7, v45
    v_lshlrev_b32 v6, 16, v81
    v_and_b32 v7, 0xffff0000, v81
    v_fmac_f32 v70, v6, v45
    v_fmac_f32 v71, v7, v45
    v_lshlrev_b32 v6, 16, v82
    v_and_b32 v7, 0xffff0000, v82
    v_fmac_f32 v72, v6, v45
    v_fmac_f32 v73, v7, v45
    v_lshlrev_b32 v6, 16, v83
    v_and_b32 v7, 0xffff0000, v83
    v_fmac_f32 v74, v6, v45
    v_fmac_f32 v75, v7, v45
    s_waitcnt vmcnt(13)
    v_lshlrev_b32 v6, 16, v84
    v_and_b32 v7, 0xffff0000, v84
    v_fmac_f32 v68, v6, v46
    v_fmac_f32 v69, v7, v46
    v_lshlrev_b32 v6, 16, v85
    v_and_b32 v7, 0xffff0000, v85
    v_fmac_f32 v70, v6, v46
    v_fmac_f32 v71, v7, v46
    v_lshlrev_b32 v6, 16, v86
    v_and_b32 v7, 0xffff0000, v86
    v_fmac_f32 v72, v6, v46
    v_fmac_f32 v73, v7, v46
    v_lshlrev_b32 v6, 16, v87
    v_and_b32 v7, 0xffff0000, v87
    v_fmac_f32 v74, v6, v46
    v_fmac_f32 v75, v7, v46
    s_waitcnt vmcnt(12)
    v_lshlrev_b32 v6, 16, v88
    v_and_b32 v7, 0xffff0000, v88
    v_fmac_f32 v68, v6, v47
    v_fmac_f32 v69, v7, v47
    v_lshlrev_b32 v6, 16, v89
    v_and_b32 v7, 0xffff0000, v89
    v_fmac_f32 v70, v6, v47
    v_fmac_f32 v71, v7, v47
    v_lshlrev_b32 v6, 16, v90
    v_and_b32 v7, 0xffff0000, v90
    v_fmac_f32 v72, v6, v47
    v_fmac_f32 v73, v7, v47
    v_lshlrev_b32 v6, 16, v91
    v_and_b32 v7, 0xffff0000, v91
    v_fmac_f32 v74, v6, v47
    v_fmac_f32 v75, v7, v47
    s_waitcnt vmcnt(11)
    v_lshlrev_b32 v6, 16, v92
    v_and_b32 v7, 0xffff0000, v92
    v_fmac_f32 v68, v6, v48
    v_fmac_f32 v69, v7, v48
    v_lshlrev_b32 v6, 16, v93
    v_and_b32 v7, 0xffff0000, v93
    v_fmac_f32 v70, v6, v48
    v_fmac_f32 v71, v7, v48
    v_lshlrev_b32 v6, 16, v94
    v_and_b32 v7, 0xffff0000, v94
    v_fmac_f32 v72, v6, v48
    v_fmac_f32 v73, v7, v48
    v_lshlrev_b32 v6, 16, v95
    v_and_b32 v7, 0xffff0000, v95
    v_fmac_f32 v74, v6, v48
    v_fmac_f32 v75, v7, v48
    s_waitcnt vmcnt(10)
    v_lshlrev_b32 v6, 16, v96
    v_and_b32 v7, 0xffff0000, v96
    v_fmac_f32 v68, v6, v49
    v_fmac_f32 v69, v7, v49
    v_lshlrev_b32 v6, 16, v97
    v_and_b32 v7, 0xffff0000, v97
    v_fmac_f32 v70, v6, v49
    v_fmac_f32 v71, v7, v49
    v_lshlrev_b32 v6, 16, v98
    v_and_b32 v7, 0xffff0000, v98
    v_fmac_f32 v72, v6, v49
    v_fmac_f32 v73, v7, v49
    v_lshlrev_b32 v6, 16, v99
    v_and_b32 v7, 0xffff0000, v99
    v_fmac_f32 v74, v6, v49
    v_fmac_f32 v75, v7, v49
    s_waitcnt vmcnt(9)
    v_lshlrev_b32 v6, 16, v100
    v_and_b32 v7, 0xffff0000, v100
    v_fmac_f32 v68, v6, v50
    v_fmac_f32 v69, v7, v50
    v_lshlrev_b32 v6, 16, v101
    v_and_b32 v7, 0xffff0000, v101
    v_fmac_f32 v70, v6, v50
    v_fmac_f32 v71, v7, v50
    v_lshlrev_b32 v6, 16, v102
    v_and_b32 v7, 0xffff0000, v102
    v_fmac_f32 v72, v6, v50
    v_fmac_f32 v73, v7, v50
    v_lshlrev_b32 v6, 16, v103
    v_and_b32 v7, 0xffff0000, v103
    v_fmac_f32 v74, v6, v50
    v_fmac_f32 v75, v7, v50
    s_waitcnt vmcnt(8)
    v_lshlrev_b32 v6, 16, v104
    v_and_b32 v7, 0xffff0000, v104
    v_fmac_f32 v68, v6, v51
    v_fmac_f32 v69, v7, v51
    v_lshlrev_b32 v6, 16, v105
    v_and_b32 v7, 0xffff0000, v105
    v_fmac_f32 v70, v6, v51
    v_fmac_f32 v71, v7, v51
    v_lshlrev_b32 v6, 16, v106
    v_and_b32 v7, 0xffff0000, v106
    v_fmac_f32 v72, v6, v51
    v_fmac_f32 v73, v7, v51
    v_lshlrev_b32 v6, 16, v107
    v_and_b32 v7, 0xffff0000, v107
    v_fmac_f32 v74, v6, v51
    v_fmac_f32 v75, v7, v51
    s_waitcnt vmcnt(7)
    v_lshlrev_b32 v6, 16, v108
    v_and_b32 v7, 0xffff0000, v108
    v_fmac_f32 v68, v6, v52
    v_fmac_f32 v69, v7, v52
    v_lshlrev_b32 v6, 16, v109
    v_and_b32 v7, 0xffff0000, v109
    v_fmac_f32 v70, v6, v52
    v_fmac_f32 v71, v7, v52
    v_lshlrev_b32 v6, 16, v110
    v_and_b32 v7, 0xffff0000, v110
    v_fmac_f32 v72, v6, v52
    v_fmac_f32 v73, v7, v52
    v_lshlrev_b32 v6, 16, v111
    v_and_b32 v7, 0xffff0000, v111
    v_fmac_f32 v74, v6, v52
    v_fmac_f32 v75, v7, v52
    s_waitcnt vmcnt(6)
    v_lshlrev_b32 v6, 16, v112
    v_and_b32 v7, 0xffff0000, v112
    v_fmac_f32 v68, v6, v53
    v_fmac_f32 v69, v7, v53
    v_lshlrev_b32 v6, 16, v113
    v_and_b32 v7, 0xffff0000, v113
    v_fmac_f32 v70, v6, v53
    v_fmac_f32 v71, v7, v53
    v_lshlrev_b32 v6, 16, v114
    v_and_b32 v7, 0xffff0000, v114
    v_fmac_f32 v72, v6, v53
    v_fmac_f32 v73, v7, v53
    v_lshlrev_b32 v6, 16, v115
    v_and_b32 v7, 0xffff0000, v115
    v_fmac_f32 v74, v6, v53
    v_fmac_f32 v75, v7, v53
    s_waitcnt vmcnt(5)
    v_lshlrev_b32 v6, 16, v116
    v_and_b32 v7, 0xffff0000, v116
    v_fmac_f32 v68, v6, v54
    v_fmac_f32 v69, v7, v54
    v_lshlrev_b32 v6, 16, v117
    v_and_b32 v7, 0xffff0000, v117
    v_fmac_f32 v70, v6, v54
    v_fmac_f32 v71, v7, v54
    v_lshlrev_b32 v6, 16, v118
    v_and_b32 v7, 0xffff0000, v118
    v_fmac_f32 v72, v6, v54
    v_fmac_f32 v73, v7, v54
    v_lshlrev_b32 v6, 16, v119
    v_and_b32 v7, 0xffff0000, v119
    v_fmac_f32 v74, v6, v54
    v_fmac_f32 v75, v7, v54
    s_waitcnt vmcnt(4)
    v_lshlrev_b32 v6, 16, v120
    v_and_b32 v7, 0xffff0000, v120
    v_fmac_f32 v68, v6, v55
    v_fmac_f32 v69, v7, v55
    v_lshlrev_b32 v6, 16, v121
    v_and_b32 v7, 0xffff0000, v121
    v_fmac_f32 v70, v6, v55
    v_fmac_f32 v71, v7, v55
    v_lshlrev_b32 v6, 16, v122
    v_and_b32 v7, 0xffff0000, v122
    v_fmac_f32 v72, v6, v55
    v_fmac_f32 v73, v7, v55
    v_lshlrev_b32 v6, 16, v123
    v_and_b32 v7, 0xffff0000, v123
    v_fmac_f32 v74, v6, v55
    v_fmac_f32 v75, v7, v55
    s_waitcnt vmcnt(3)
    v_lshlrev_b32 v6, 16, v28
    v_and_b32 v7, 0xffff0000, v28
    v_fmac_f32 v68, v6, v56
    v_fmac_f32 v69, v7, v56
    v_lshlrev_b32 v6, 16, v29
    v_and_b32 v7, 0xffff0000, v29
    v_fmac_f32 v70, v6, v56
    v_fmac_f32 v71, v7, v56
    v_lshlrev_b32 v6, 16, v30
    v_and_b32 v7, 0xffff0000, v30
    v_fmac_f32 v72, v6, v56
    v_fmac_f32 v73, v7, v56
    v_lshlrev_b32 v6, 16, v31
    v_and_b32 v7, 0xffff0000, v31
    v_fmac_f32 v74, v6, v56
    v_fmac_f32 v75, v7, v56
    s_waitcnt vmcnt(2)
    v_lshlrev_b32 v6, 16, v32
    v_and_b32 v7, 0xffff0000, v32
    v_fmac_f32 v68, v6, v57
    v_fmac_f32 v69, v7, v57
    v_lshlrev_b32 v6, 16, v33
    v_and_b32 v7, 0xffff0000, v33
    v_fmac_f32 v70, v6, v57
    v_fmac_f32 v71, v7, v57
    v_lshlrev_b32 v6, 16, v34
    v_and_b32 v7, 0xffff0000, v34
    v_fmac_f32 v72, v6, v57
    v_fmac_f32 v73, v7, v57
    v_lshlrev_b32 v6, 16, v35
    v_and_b32 v7, 0xffff0000, v35
    v_fmac_f32 v74, v6, v57
    v_fmac_f32 v75, v7, v57
    s_waitcnt vmcnt(1)
    v_lshlrev_b32 v6, 16, v36
    v_and_b32 v7, 0xffff0000, v36
    v_fmac_f32 v68, v6, v58
    v_fmac_f32 v69, v7, v58
    v_lshlrev_b32 v6, 16, v37
    v_and_b32 v7, 0xffff0000, v37
    v_fmac_f32 v70, v6, v58
    v_fmac_f32 v71, v7, v58
    v_lshlrev_b32 v6, 16, v38
    v_and_b32 v7, 0xffff0000, v38
    v_fmac_f32 v72, v6, v58
    v_fmac_f32 v73, v7, v58
    v_lshlrev_b32 v6, 16, v39
    v_and_b32 v7, 0xffff0000, v39
    v_fmac_f32 v74, v6, v58
    v_fmac_f32 v75, v7, v58
    s_waitcnt vmcnt(0)
    v_lshlrev_b32 v6, 16, v40
    v_and_b32 v7, 0xffff0000, v40
    v_fmac_f32 v68, v6, v59
    v_fmac_f32 v69, v7, v59
    v_lshlrev_b32 v6, 16, v41
    v_and_b32 v7, 0xffff0000, v41
    v_fmac_f32 v70, v6, v59
    v_fmac_f32 v71, v7, v59
    v_lshlrev_b32 v6, 16, v42
    v_and_b32 v7, 0xffff0000, v42
    v_fmac_f32 v72, v6, v59
    v_fmac_f32 v73, v7, v59
    v_lshlrev_b32 v6, 16, v43
    v_and_b32 v7, 0xffff0000, v43
    v_fmac_f32 v74, v6, v59
    v_fmac_f32 v75, v7, v59
    s_lshl_b32 s15, s12, 11
    v_lshlrev_b32 v2, 9, v125
    v_lshl_add_u32 v2, v124, 5, v2
    v_add_u32 v2, s15, v2
    ds_write_b128 v2, v[68:71] offset:19456
    ds_write_b128 v2, v[72:75] offset:19472
    s_waitcnt lgkmcnt(0)
    v_mov_b32 v2, 0
    v_mov_b32 v3, 1
    v_cmp_eq_u32 vcc, 0, v1
    s_and_saveexec_b64 s[84:85], vcc
    ds_add_u32 v2, v3 offset:2692
    s_mov_b64 exec, s[84:85]
    s_cmp_gt_u32 s12, 1
    s_cbranch_scc1 L_st2_done
L_spin1:
    ds_read_b32 v4, v2 offset:2692
    s_waitcnt lgkmcnt(0)
    v_readfirstlane_b32 s15, v4
    s_cmp_lt_u32 s15, 8
    s_cbranch_scc1 L_spin1
    v_lshlrev_b32 v2, 2, v0
    ds_read_b32 v28, v2 offset:19456
    ds_read_b32 v29, v2 offset:19968
    ds_read_b32 v30, v2 offset:20480
    ds_read_b32 v31, v2 offset:20992
    ds_read_b32 v32, v2 offset:21504
    ds_read_b32 v33, v2 offset:22016
    ds_read_b32 v34, v2 offset:22528
    ds_read_b32 v35, v2 offset:23040
    ds_read_b32 v36, v2 offset:23552
    ds_read_b32 v37, v2 offset:24064
    ds_read_b32 v38, v2 offset:24576
    ds_read_b32 v39, v2 offset:25088
    ds_read_b32 v40, v2 offset:25600
    ds_read_b32 v41, v2 offset:26112
    ds_read_b32 v42, v2 offset:26624
    ds_read_b32 v43, v2 offset:27136
    s_waitcnt lgkmcnt(0)
    v_mov_b32 v3, v28
    v_add_f32 v3, v3, v29
    v_add_f32 v3, v3, v30
    v_add_f32 v3, v3, v31
    v_add_f32 v3, v3, v32
    v_add_f32 v3, v3, v33
    v_add_f32 v3, v3, v34
    v_add_f32 v3, v3, v35
    v_add_f32 v3, v3, v36
    v_add_f32 v3, v3, v37
    v_add_f32 v3, v3, v38
    v_add_f32 v3, v3, v39
    v_add_f32 v3, v3, v40
    v_add_f32 v3, v3, v41
    v_add_f32 v3, v3, v42
    v_add_f32 v3, v3, v43
    ds_read_b32 v28, v2 offset:27648
    ds_read_b32 v29, v2 offset:28160
    ds_read_b32 v30, v2 offset:28672
    ds_read_b32 v31, v2 offset:29184
    ds_read_b32 v32, v2 offset:29696
    ds_read_b32 v33, v2 offset:30208
    ds_read_b32 v34, v2 offset:30720
    ds_read_b32 v35, v2 offset:31232
    ds_read_b32 v36, v2 offset:31744
    ds_read_b32 v37, v2 offset:32256
    ds_read_b32 v38, v2 offset:32768
    ds_read_b32 v39, v2 offset:33280
    ds_read_b32 v40, v2 offset:33792
    ds_read_b32 v41, v2 offset:34304
    ds_read_b32 v42, v2 offset:34816
    ds_read_b32 v43, v2 offset:35328
    s_waitcnt lgkmcnt(0)
    v_add_f32 v3, v3, v28
    v_add_f32 v3, v3, v29
    v_add_f32 v3, v3, v30
    v_add_f32 v3, v3, v31
    v_add_f32 v3, v3, v32
    v_add_f32 v3, v3, v33
    v_add_f32 v3, v3, v34
    v_add_f32 v3, v3, v35
    v_add_f32 v3, v3, v36
    v_add_f32 v3, v3, v37
    v_add_f32 v3, v3, v38
    v_add_f32 v3, v3, v39
    v_add_f32 v3, v3, v40
    v_add_f32 v3, v3, v41
    v_add_f32 v3, v3, v42
    v_add_f32 v3, v3, v43
    v_cvt_pk_bf16_f32 v3, v3, v3
    v_lshlrev_b32 v2, 1, v0
    ds_write_b16 v2, v3 offset:2048
    s_waitcnt lgkmcnt(0)
    v_mov_b32 v2, 0
    v_mov_b32 v3, 1
    v_cmp_eq_u32 vcc, 0, v1
    s_and_saveexec_b64 s[84:85], vcc
    ds_add_u32 v2, v3 offset:2696
    s_mov_b64 exec, s[84:85]
L_st2_done:
    s_mov_b32 s72, 0
    buffer_load_dwordx4 v[76:79], v9, s[4:7], s72 offen offset:0 nt
    s_mov_b32 s72, 0
    buffer_load_dwordx4 v[80:83], v9, s[4:7], s72 offen offset:1024 nt
    s_mov_b32 s72, 0
    buffer_load_dwordx4 v[84:87], v9, s[4:7], s72 offen offset:2048 nt
    s_mov_b32 s72, 0
    buffer_load_dwordx4 v[88:91], v9, s[4:7], s72 offen offset:3072 nt
    s_mov_b32 s72, 4096
    buffer_load_dwordx4 v[92:95], v9, s[4:7], s72 offen offset:0 nt
    s_mov_b32 s72, 4096
    buffer_load_dwordx4 v[96:99], v9, s[4:7], s72 offen offset:1024 nt
    s_mov_b32 s72, 4096
    buffer_load_dwordx4 v[100:103], v9, s[4:7], s72 offen offset:2048 nt
    s_mov_b32 s72, 4096
    buffer_load_dwordx4 v[104:107], v9, s[4:7], s72 offen offset:3072 nt
    s_mov_b32 s72, 8192
    buffer_load_dwordx4 v[108:111], v9, s[4:7], s72 offen offset:0 nt
    s_mov_b32 s72, 8192
    buffer_load_dwordx4 v[112:115], v9, s[4:7], s72 offen offset:1024 nt
    s_mov_b32 s72, 8192
    buffer_load_dwordx4 v[116:119], v9, s[4:7], s72 offen offset:2048 nt
    s_mov_b32 s72, 8192
    buffer_load_dwordx4 v[120:123], v9, s[4:7], s72 offen offset:3072 nt
L_qdone:
    v_mov_b32 v2, 0
L_spin2:
    ds_read_b32 v4, v2 offset:2696
    s_waitcnt lgkmcnt(0)
    v_readfirstlane_b32 s15, v4
    s_cmp_lt_u32 s15, 2
    s_cbranch_scc0 L_spin2d
    s_sleep 2
    s_branch L_spin2
L_spin2d:
    v_lshlrev_b32 v2, 4, v124
    ds_read_b128 v[16:19], v2 offset:2048
    v_mov_b32 v8, 0xff800000
    v_and_b32 v2, 31, v1
    v_min_u32 v2, 21, v2
    v_lshlrev_b32 v2, 2, v2
    s_mul_i32 s15, s14, 86
    s_and_b32 s15, s15, -4
    s_mul_i32 s73, s12, 88064
    s_add_u32 s15, s15, s73
    v_add_u32 v2, s15, v2
    v_mov_b32 v4, s28
    v_mov_b32 v5, s29
    v_mov_b32 v6, s30
    v_mov_b32 v7, s31
    v_cmp_gt_u32 vcc, 32, v1
    s_nop 1
    v_cndmask_b32 v4, v6, v4, vcc
    v_cndmask_b32 v5, v7, v5, vcc
    v_add_co_u32 v4, vcc, v2, v4
    s_nop 1
    v_addc_co_u32 v5, vcc, 0, v5, vcc
    global_load_dword v44, v[4:5], off
    v_add_co_u32 v4, vcc, 2752, v4
    s_nop 1
    v_addc_co_u32 v5, vcc, 0, v5, vcc
    global_load_dword v45, v[4:5], off
    v_add_co_u32 v4, vcc, 2752, v4
    s_nop 1
    v_addc_co_u32 v5, vcc, 0, v5, vcc
    global_load_dword v46, v[4:5], off
    v_add_co_u32 v4, vcc, 2752, v4
    s_nop 1
    v_addc_co_u32 v5, vcc, 0, v5, vcc
    global_load_dword v47, v[4:5], off
    v_add_co_u32 v4, vcc, 2752, v4
    s_nop 1
    v_addc_co_u32 v5, vcc, 0, v5, vcc
    global_load_dword v48, v[4:5], off
    v_add_co_u32 v4, vcc, 2752, v4
    s_nop 1
    v_addc_co_u32 v5, vcc, 0, v5, vcc
    global_load_dword v49, v[4:5], off
    v_add_co_u32 v4, vcc, 2752, v4
    s_nop 1
    v_addc_co_u32 v5, vcc, 0, v5, vcc
    global_load_dword v50, v[4:5], off
    v_add_co_u32 v4, vcc, 2752, v4
    s_nop 1
    v_addc_co_u32 v5, vcc, 0, v5, vcc
    global_load_dword v51, v[4:5], off
    v_add_co_u32 v4, vcc, 2752, v4
    s_nop 1
    v_addc_co_u32 v5, vcc, 0, v5, vcc
    global_load_dword v52, v[4:5], off
    v_add_co_u32 v4, vcc, 2752, v4
    s_nop 1
    v_addc_co_u32 v5, vcc, 0, v5, vcc
    global_load_dword v53, v[4:5], off
    v_add_co_u32 v4, vcc, 2752, v4
    s_nop 1
    v_addc_co_u32 v5, vcc, 0, v5, vcc
    global_load_dword v54, v[4:5], off
    v_add_co_u32 v4, vcc, 2752, v4
    s_nop 1
    v_addc_co_u32 v5, vcc, 0, v5, vcc
    global_load_dword v55, v[4:5], off
    v_add_co_u32 v4, vcc, 2752, v4
    s_nop 1
    v_addc_co_u32 v5, vcc, 0, v5, vcc
    global_load_dword v56, v[4:5], off
    v_add_co_u32 v4, vcc, 2752, v4
    s_nop 1
    v_addc_co_u32 v5, vcc, 0, v5, vcc
    global_load_dword v57, v[4:5], off
    v_add_co_u32 v4, vcc, 2752, v4
    s_nop 1
    v_addc_co_u32 v5, vcc, 0, v5, vcc
    global_load_dword v58, v[4:5], off
    v_add_co_u32 v4, vcc, 2752, v4
    s_nop 1
    v_addc_co_u32 v5, vcc, 0, v5, vcc
    global_load_dword v59, v[4:5], off
    v_add_co_u32 v4, vcc, 2752, v4
    s_nop 1
    v_addc_co_u32 v5, vcc, 0, v5, vcc
    global_load_dword v60, v[4:5], off
    v_add_co_u32 v4, vcc, 2752, v4
    s_nop 1
    v_addc_co_u32 v5, vcc, 0, v5, vcc
    global_load_dword v61, v[4:5], off
    v_add_co_u32 v4, vcc, 2752, v4
    s_nop 1
    v_addc_co_u32 v5, vcc, 0, v5, vcc
    global_load_dword v62, v[4:5], off
    v_add_co_u32 v4, vcc, 2752, v4
    s_nop 1
    v_addc_co_u32 v5, vcc, 0, v5, vcc
    global_load_dword v63, v[4:5], off
    v_add_co_u32 v4, vcc, 2752, v4
    s_nop 1
    v_addc_co_u32 v5, vcc, 0, v5, vcc
    global_load_dword v64, v[4:5], off
    v_add_co_u32 v4, vcc, 2752, v4
    s_nop 1
    v_addc_co_u32 v5, vcc, 0, v5, vcc
    global_load_dword v65, v[4:5], off
    v_add_co_u32 v4, vcc, 2752, v4
    s_nop 1
    v_addc_co_u32 v5, vcc, 0, v5, vcc
    global_load_dword v66, v[4:5], off
    v_add_co_u32 v4, vcc, 2752, v4
    s_nop 1
    v_addc_co_u32 v5, vcc, 0, v5, vcc
    global_load_dword v67, v[4:5], off
    v_add_co_u32 v4, vcc, 2752, v4
    s_nop 1
    v_addc_co_u32 v5, vcc, 0, v5, vcc
    global_load_dword v68, v[4:5], off
    v_add_co_u32 v4, vcc, 2752, v4
    s_nop 1
    v_addc_co_u32 v5, vcc, 0, v5, vcc
    global_load_dword v69, v[4:5], off
    v_add_co_u32 v4, vcc, 2752, v4
    s_nop 1
    v_addc_co_u32 v5, vcc, 0, v5, vcc
    global_load_dword v70, v[4:5], off
    v_add_co_u32 v4, vcc, 2752, v4
    s_nop 1
    v_addc_co_u32 v5, vcc, 0, v5, vcc
    global_load_dword v71, v[4:5], off
    v_add_co_u32 v4, vcc, 2752, v4
    s_nop 1
    v_addc_co_u32 v5, vcc, 0, v5, vcc
    global_load_dword v72, v[4:5], off
    v_add_co_u32 v4, vcc, 2752, v4
    s_nop 1
    v_addc_co_u32 v5, vcc, 0, v5, vcc
    global_load_dword v73, v[4:5], off
    v_add_co_u32 v4, vcc, 2752, v4
    s_nop 1
    v_addc_co_u32 v5, vcc, 0, v5, vcc
    global_load_dword v74, v[4:5], off
    v_add_co_u32 v4, vcc, 2752, v4
    s_nop 1
    v_addc_co_u32 v5, vcc, 0, v5, vcc
    global_load_dword v75, v[4:5], off
    s_waitcnt lgkmcnt(0)
    s_waitcnt vmcnt(43)
    v_dot2_f32_bf16 v2, v76, v16, 0
    v_dot2_f32_bf16 v2, v77, v17, v2
    v_dot2_f32_bf16 v2, v78, v18, v2
    v_dot2_f32_bf16 v2, v79, v19, v2
    s_mov_b32 s72, 12288
    buffer_load_dwordx4 v[76:79], v9, s[4:7], s72 offen offset:0 nt
    s_waitcnt vmcnt(43)
    v_dot2_f32_bf16 v3, v80, v16, 0
    v_dot2_f32_bf16 v3, v81, v17, v3
    v_dot2_f32_bf16 v3, v82, v18, v3
    v_dot2_f32_bf16 v3, v83, v19, v3
    s_mov_b32 s72, 12288
    buffer_load_dwordx4 v[80:83], v9, s[4:7], s72 offen offset:1024 nt
    s_waitcnt vmcnt(43)
    v_dot2_f32_bf16 v4, v84, v16, 0
    v_dot2_f32_bf16 v4, v85, v17, v4
    v_dot2_f32_bf16 v4, v86, v18, v4
    v_dot2_f32_bf16 v4, v87, v19, v4
    s_mov_b32 s72, 12288
    buffer_load_dwordx4 v[84:87], v9, s[4:7], s72 offen offset:2048 nt
    s_waitcnt vmcnt(43)
    v_dot2_f32_bf16 v5, v88, v16, 0
    v_dot2_f32_bf16 v5, v89, v17, v5
    v_dot2_f32_bf16 v5, v90, v18, v5
    v_dot2_f32_bf16 v5, v91, v19, v5
    s_mov_b32 s72, 12288
    buffer_load_dwordx4 v[88:91], v9, s[4:7], s72 offen offset:3072 nt
    v_add_f32_dpp v2, v2, v2 row_ror:8 row_mask:0xf bank_mask:0xf
    v_add_f32_dpp v3, v3, v3 row_ror:8 row_mask:0xf bank_mask:0xf
    v_add_f32_dpp v4, v4, v4 row_ror:8 row_mask:0xf bank_mask:0xf
    v_add_f32_dpp v5, v5, v5 row_ror:8 row_mask:0xf bank_mask:0xf
    v_add_f32_dpp v2, v2, v2 row_ror:4 row_mask:0xf bank_mask:0xf
    v_add_f32_dpp v3, v3, v3 row_ror:4 row_mask:0xf bank_mask:0xf
    v_add_f32_dpp v4, v4, v4 row_ror:4 row_mask:0xf bank_mask:0xf
    v_add_f32_dpp v5, v5, v5 row_ror:4 row_mask:0xf bank_mask:0xf
    v_add_f32_dpp v2, v2, v2 row_ror:2 row_mask:0xf bank_mask:0xf
    v_add_f32_dpp v3, v3, v3 row_ror:2 row_mask:0xf bank_mask:0xf
    v_add_f32_dpp v4, v4, v4 row_ror:2 row_mask:0xf bank_mask:0xf
    v_add_f32_dpp v5, v5, v5 row_ror:2 row_mask:0xf bank_mask:0xf
    v_add_f32_dpp v2, v2, v2 row_ror:1 row_mask:0xf bank_mask:0xf
    v_add_f32_dpp v3, v3, v3 row_ror:1 row_mask:0xf bank_mask:0xf
    v_add_f32_dpp v4, v4, v4 row_ror:1 row_mask:0xf bank_mask:0xf
    v_add_f32_dpp v5, v5, v5 row_ror:1 row_mask:0xf bank_mask:0xf
    v_cvt_pk_bf16_f32 v6, v2, v3
    v_cvt_pk_bf16_f32 v7, v4, v5
    v_lshlrev_b32 v2, 16, v6
    v_and_b32 v3, 0xffff0000, v6
    v_lshlrev_b32 v4, 16, v7
    v_and_b32 v5, 0xffff0000, v7
    v_mul_f32 v2, 0x3db504f3, v2
    v_mul_f32 v3, 0x3db504f3, v3
    v_mul_f32 v4, 0x3db504f3, v4
    v_mul_f32 v5, 0x3db504f3, v5
    v_cvt_pk_bf16_f32 v28, v2, v3
    v_cvt_pk_bf16_f32 v29, v4, v5
    v_lshlrev_b32 v2, 16, v28
    v_and_b32 v3, 0xffff0000, v28
    v_lshlrev_b32 v4, 16, v29
    v_and_b32 v5, 0xffff0000, v29
    v_max3_f32 v8, v2, v3, v8
    v_max3_f32 v8, v4, v5, v8
    s_waitcnt vmcnt(43)
    v_dot2_f32_bf16 v2, v92, v16, 0
    v_dot2_f32_bf16 v2, v93, v17, v2
    v_dot2_f32_bf16 v2, v94, v18, v2
    v_dot2_f32_bf16 v2, v95, v19, v2
    s_mov_b32 s72, 16384
    buffer_load_dwordx4 v[92:95], v9, s[4:7], s72 offen offset:0 nt
    s_waitcnt vmcnt(43)
    v_dot2_f32_bf16 v3, v96, v16, 0
    v_dot2_f32_bf16 v3, v97, v17, v3
    v_dot2_f32_bf16 v3, v98, v18, v3
    v_dot2_f32_bf16 v3, v99, v19, v3
    s_mov_b32 s72, 16384
    buffer_load_dwordx4 v[96:99], v9, s[4:7], s72 offen offset:1024 nt
    s_waitcnt vmcnt(43)
    v_dot2_f32_bf16 v4, v100, v16, 0
    v_dot2_f32_bf16 v4, v101, v17, v4
    v_dot2_f32_bf16 v4, v102, v18, v4
    v_dot2_f32_bf16 v4, v103, v19, v4
    s_mov_b32 s72, 16384
    buffer_load_dwordx4 v[100:103], v9, s[4:7], s72 offen offset:2048 nt
    s_waitcnt vmcnt(43)
    v_dot2_f32_bf16 v5, v104, v16, 0
    v_dot2_f32_bf16 v5, v105, v17, v5
    v_dot2_f32_bf16 v5, v106, v18, v5
    v_dot2_f32_bf16 v5, v107, v19, v5
    s_mov_b32 s72, 16384
    buffer_load_dwordx4 v[104:107], v9, s[4:7], s72 offen offset:3072 nt
    v_add_f32_dpp v2, v2, v2 row_ror:8 row_mask:0xf bank_mask:0xf
    v_add_f32_dpp v3, v3, v3 row_ror:8 row_mask:0xf bank_mask:0xf
    v_add_f32_dpp v4, v4, v4 row_ror:8 row_mask:0xf bank_mask:0xf
    v_add_f32_dpp v5, v5, v5 row_ror:8 row_mask:0xf bank_mask:0xf
    v_add_f32_dpp v2, v2, v2 row_ror:4 row_mask:0xf bank_mask:0xf
    v_add_f32_dpp v3, v3, v3 row_ror:4 row_mask:0xf bank_mask:0xf
    v_add_f32_dpp v4, v4, v4 row_ror:4 row_mask:0xf bank_mask:0xf
    v_add_f32_dpp v5, v5, v5 row_ror:4 row_mask:0xf bank_mask:0xf
    v_add_f32_dpp v2, v2, v2 row_ror:2 row_mask:0xf bank_mask:0xf
    v_add_f32_dpp v3, v3, v3 row_ror:2 row_mask:0xf bank_mask:0xf
    v_add_f32_dpp v4, v4, v4 row_ror:2 row_mask:0xf bank_mask:0xf
    v_add_f32_dpp v5, v5, v5 row_ror:2 row_mask:0xf bank_mask:0xf
    v_add_f32_dpp v2, v2, v2 row_ror:1 row_mask:0xf bank_mask:0xf
    v_add_f32_dpp v3, v3, v3 row_ror:1 row_mask:0xf bank_mask:0xf
    v_add_f32_dpp v4, v4, v4 row_ror:1 row_mask:0xf bank_mask:0xf
    v_add_f32_dpp v5, v5, v5 row_ror:1 row_mask:0xf bank_mask:0xf
    v_cvt_pk_bf16_f32 v6, v2, v3
    v_cvt_pk_bf16_f32 v7, v4, v5
    v_lshlrev_b32 v2, 16, v6
    v_and_b32 v3, 0xffff0000, v6
    v_lshlrev_b32 v4, 16, v7
    v_and_b32 v5, 0xffff0000, v7
    v_mul_f32 v2, 0x3db504f3, v2
    v_mul_f32 v3, 0x3db504f3, v3
    v_mul_f32 v4, 0x3db504f3, v4
    v_mul_f32 v5, 0x3db504f3, v5
    v_cvt_pk_bf16_f32 v30, v2, v3
    v_cvt_pk_bf16_f32 v31, v4, v5
    v_lshlrev_b32 v2, 16, v30
    v_and_b32 v3, 0xffff0000, v30
    v_lshlrev_b32 v4, 16, v31
    v_and_b32 v5, 0xffff0000, v31
    v_max3_f32 v8, v2, v3, v8
    v_max3_f32 v8, v4, v5, v8
    s_waitcnt vmcnt(43)
    v_dot2_f32_bf16 v2, v108, v16, 0
    v_dot2_f32_bf16 v2, v109, v17, v2
    v_dot2_f32_bf16 v2, v110, v18, v2
    v_dot2_f32_bf16 v2, v111, v19, v2
    s_mov_b32 s72, 20480
    buffer_load_dwordx4 v[108:111], v9, s[4:7], s72 offen offset:0 nt
    s_waitcnt vmcnt(43)
    v_dot2_f32_bf16 v3, v112, v16, 0
    v_dot2_f32_bf16 v3, v113, v17, v3
    v_dot2_f32_bf16 v3, v114, v18, v3
    v_dot2_f32_bf16 v3, v115, v19, v3
    s_mov_b32 s72, 20480
    buffer_load_dwordx4 v[112:115], v9, s[4:7], s72 offen offset:1024 nt
    s_waitcnt vmcnt(43)
    v_dot2_f32_bf16 v4, v116, v16, 0
    v_dot2_f32_bf16 v4, v117, v17, v4
    v_dot2_f32_bf16 v4, v118, v18, v4
    v_dot2_f32_bf16 v4, v119, v19, v4
    s_mov_b32 s72, 20480
    buffer_load_dwordx4 v[116:119], v9, s[4:7], s72 offen offset:2048 nt
    s_waitcnt vmcnt(43)
    v_dot2_f32_bf16 v5, v120, v16, 0
    v_dot2_f32_bf16 v5, v121, v17, v5
    v_dot2_f32_bf16 v5, v122, v18, v5
    v_dot2_f32_bf16 v5, v123, v19, v5
    s_mov_b32 s72, 20480
    buffer_load_dwordx4 v[120:123], v9, s[4:7], s72 offen offset:3072 nt
    v_add_f32_dpp v2, v2, v2 row_ror:8 row_mask:0xf bank_mask:0xf
    v_add_f32_dpp v3, v3, v3 row_ror:8 row_mask:0xf bank_mask:0xf
    v_add_f32_dpp v4, v4, v4 row_ror:8 row_mask:0xf bank_mask:0xf
    v_add_f32_dpp v5, v5, v5 row_ror:8 row_mask:0xf bank_mask:0xf
    v_add_f32_dpp v2, v2, v2 row_ror:4 row_mask:0xf bank_mask:0xf
    v_add_f32_dpp v3, v3, v3 row_ror:4 row_mask:0xf bank_mask:0xf
    v_add_f32_dpp v4, v4, v4 row_ror:4 row_mask:0xf bank_mask:0xf
    v_add_f32_dpp v5, v5, v5 row_ror:4 row_mask:0xf bank_mask:0xf
    v_add_f32_dpp v2, v2, v2 row_ror:2 row_mask:0xf bank_mask:0xf
    v_add_f32_dpp v3, v3, v3 row_ror:2 row_mask:0xf bank_mask:0xf
    v_add_f32_dpp v4, v4, v4 row_ror:2 row_mask:0xf bank_mask:0xf
    v_add_f32_dpp v5, v5, v5 row_ror:2 row_mask:0xf bank_mask:0xf
    v_add_f32_dpp v2, v2, v2 row_ror:1 row_mask:0xf bank_mask:0xf
    v_add_f32_dpp v3, v3, v3 row_ror:1 row_mask:0xf bank_mask:0xf
    v_add_f32_dpp v4, v4, v4 row_ror:1 row_mask:0xf bank_mask:0xf
    v_add_f32_dpp v5, v5, v5 row_ror:1 row_mask:0xf bank_mask:0xf
    v_cvt_pk_bf16_f32 v6, v2, v3
    v_cvt_pk_bf16_f32 v7, v4, v5
    v_lshlrev_b32 v2, 16, v6
    v_and_b32 v3, 0xffff0000, v6
    v_lshlrev_b32 v4, 16, v7
    v_and_b32 v5, 0xffff0000, v7
    v_mul_f32 v2, 0x3db504f3, v2
    v_mul_f32 v3, 0x3db504f3, v3
    v_mul_f32 v4, 0x3db504f3, v4
    v_mul_f32 v5, 0x3db504f3, v5
    v_cvt_pk_bf16_f32 v32, v2, v3
    v_cvt_pk_bf16_f32 v33, v4, v5
    v_lshlrev_b32 v2, 16, v32
    v_and_b32 v3, 0xffff0000, v32
    v_lshlrev_b32 v4, 16, v33
    v_and_b32 v5, 0xffff0000, v33
    v_max3_f32 v8, v2, v3, v8
    v_max3_f32 v8, v4, v5, v8
    s_waitcnt vmcnt(11)
    v_dot2_f32_bf16 v2, v76, v16, 0
    v_dot2_f32_bf16 v2, v77, v17, v2
    v_dot2_f32_bf16 v2, v78, v18, v2
    v_dot2_f32_bf16 v2, v79, v19, v2
    s_mov_b32 s72, 24576
    buffer_load_dwordx4 v[76:79], v9, s[4:7], s72 offen offset:0 nt
    s_waitcnt vmcnt(11)
    v_dot2_f32_bf16 v3, v80, v16, 0
    v_dot2_f32_bf16 v3, v81, v17, v3
    v_dot2_f32_bf16 v3, v82, v18, v3
    v_dot2_f32_bf16 v3, v83, v19, v3
    s_mov_b32 s72, 24576
    buffer_load_dwordx4 v[80:83], v9, s[4:7], s72 offen offset:1024 nt
    s_waitcnt vmcnt(11)
    v_dot2_f32_bf16 v4, v84, v16, 0
    v_dot2_f32_bf16 v4, v85, v17, v4
    v_dot2_f32_bf16 v4, v86, v18, v4
    v_dot2_f32_bf16 v4, v87, v19, v4
    s_mov_b32 s72, 24576
    buffer_load_dwordx4 v[84:87], v9, s[4:7], s72 offen offset:2048 nt
    s_waitcnt vmcnt(11)
    v_dot2_f32_bf16 v5, v88, v16, 0
    v_dot2_f32_bf16 v5, v89, v17, v5
    v_dot2_f32_bf16 v5, v90, v18, v5
    v_dot2_f32_bf16 v5, v91, v19, v5
    s_mov_b32 s72, 24576
    buffer_load_dwordx4 v[88:91], v9, s[4:7], s72 offen offset:3072 nt
    v_add_f32_dpp v2, v2, v2 row_ror:8 row_mask:0xf bank_mask:0xf
    v_add_f32_dpp v3, v3, v3 row_ror:8 row_mask:0xf bank_mask:0xf
    v_add_f32_dpp v4, v4, v4 row_ror:8 row_mask:0xf bank_mask:0xf
    v_add_f32_dpp v5, v5, v5 row_ror:8 row_mask:0xf bank_mask:0xf
    v_add_f32_dpp v2, v2, v2 row_ror:4 row_mask:0xf bank_mask:0xf
    v_add_f32_dpp v3, v3, v3 row_ror:4 row_mask:0xf bank_mask:0xf
    v_add_f32_dpp v4, v4, v4 row_ror:4 row_mask:0xf bank_mask:0xf
    v_add_f32_dpp v5, v5, v5 row_ror:4 row_mask:0xf bank_mask:0xf
    v_add_f32_dpp v2, v2, v2 row_ror:2 row_mask:0xf bank_mask:0xf
    v_add_f32_dpp v3, v3, v3 row_ror:2 row_mask:0xf bank_mask:0xf
    v_add_f32_dpp v4, v4, v4 row_ror:2 row_mask:0xf bank_mask:0xf
    v_add_f32_dpp v5, v5, v5 row_ror:2 row_mask:0xf bank_mask:0xf
    v_add_f32_dpp v2, v2, v2 row_ror:1 row_mask:0xf bank_mask:0xf
    v_add_f32_dpp v3, v3, v3 row_ror:1 row_mask:0xf bank_mask:0xf
    v_add_f32_dpp v4, v4, v4 row_ror:1 row_mask:0xf bank_mask:0xf
    v_add_f32_dpp v5, v5, v5 row_ror:1 row_mask:0xf bank_mask:0xf
    v_cvt_pk_bf16_f32 v6, v2, v3
    v_cvt_pk_bf16_f32 v7, v4, v5
    v_lshlrev_b32 v2, 16, v6
    v_and_b32 v3, 0xffff0000, v6
    v_lshlrev_b32 v4, 16, v7
    v_and_b32 v5, 0xffff0000, v7
    v_mul_f32 v2, 0x3db504f3, v2
    v_mul_f32 v3, 0x3db504f3, v3
    v_mul_f32 v4, 0x3db504f3, v4
    v_mul_f32 v5, 0x3db504f3, v5
    v_cvt_pk_bf16_f32 v34, v2, v3
    v_cvt_pk_bf16_f32 v35, v4, v5
    v_lshlrev_b32 v2, 16, v34
    v_and_b32 v3, 0xffff0000, v34
    v_lshlrev_b32 v4, 16, v35
    v_and_b32 v5, 0xffff0000, v35
    v_max3_f32 v8, v2, v3, v8
    v_max3_f32 v8, v4, v5, v8
    s_waitcnt vmcnt(11)
    v_dot2_f32_bf16 v2, v92, v16, 0
    v_dot2_f32_bf16 v2, v93, v17, v2
    v_dot2_f32_bf16 v2, v94, v18, v2
    v_dot2_f32_bf16 v2, v95, v19, v2
    s_mov_b32 s72, 28672
    buffer_load_dwordx4 v[92:95], v9, s[4:7], s72 offen offset:0 nt
    s_waitcnt vmcnt(11)
    v_dot2_f32_bf16 v3, v96, v16, 0
    v_dot2_f32_bf16 v3, v97, v17, v3
    v_dot2_f32_bf16 v3, v98, v18, v3
    v_dot2_f32_bf16 v3, v99, v19, v3
    s_mov_b32 s72, 28672
    buffer_load_dwordx4 v[96:99], v9, s[4:7], s72 offen offset:1024 nt
    s_waitcnt vmcnt(11)
    v_dot2_f32_bf16 v4, v100, v16, 0
    v_dot2_f32_bf16 v4, v101, v17, v4
    v_dot2_f32_bf16 v4, v102, v18, v4
    v_dot2_f32_bf16 v4, v103, v19, v4
    s_mov_b32 s72, 28672
    buffer_load_dwordx4 v[100:103], v9, s[4:7], s72 offen offset:2048 nt
    s_waitcnt vmcnt(11)
    v_dot2_f32_bf16 v5, v104, v16, 0
    v_dot2_f32_bf16 v5, v105, v17, v5
    v_dot2_f32_bf16 v5, v106, v18, v5
    v_dot2_f32_bf16 v5, v107, v19, v5
    s_mov_b32 s72, 28672
    buffer_load_dwordx4 v[104:107], v9, s[4:7], s72 offen offset:3072 nt
    v_add_f32_dpp v2, v2, v2 row_ror:8 row_mask:0xf bank_mask:0xf
    v_add_f32_dpp v3, v3, v3 row_ror:8 row_mask:0xf bank_mask:0xf
    v_add_f32_dpp v4, v4, v4 row_ror:8 row_mask:0xf bank_mask:0xf
    v_add_f32_dpp v5, v5, v5 row_ror:8 row_mask:0xf bank_mask:0xf
    v_add_f32_dpp v2, v2, v2 row_ror:4 row_mask:0xf bank_mask:0xf
    v_add_f32_dpp v3, v3, v3 row_ror:4 row_mask:0xf bank_mask:0xf
    v_add_f32_dpp v4, v4, v4 row_ror:4 row_mask:0xf bank_mask:0xf
    v_add_f32_dpp v5, v5, v5 row_ror:4 row_mask:0xf bank_mask:0xf
    v_add_f32_dpp v2, v2, v2 row_ror:2 row_mask:0xf bank_mask:0xf
    v_add_f32_dpp v3, v3, v3 row_ror:2 row_mask:0xf bank_mask:0xf
    v_add_f32_dpp v4, v4, v4 row_ror:2 row_mask:0xf bank_mask:0xf
    v_add_f32_dpp v5, v5, v5 row_ror:2 row_mask:0xf bank_mask:0xf
    v_add_f32_dpp v2, v2, v2 row_ror:1 row_mask:0xf bank_mask:0xf
    v_add_f32_dpp v3, v3, v3 row_ror:1 row_mask:0xf bank_mask:0xf
    v_add_f32_dpp v4, v4, v4 row_ror:1 row_mask:0xf bank_mask:0xf
    v_add_f32_dpp v5, v5, v5 row_ror:1 row_mask:0xf bank_mask:0xf
    v_cvt_pk_bf16_f32 v6, v2, v3
    v_cvt_pk_bf16_f32 v7, v4, v5
    v_lshlrev_b32 v2, 16, v6
    v_and_b32 v3, 0xffff0000, v6
    v_lshlrev_b32 v4, 16, v7
    v_and_b32 v5, 0xffff0000, v7
    v_mul_f32 v2, 0x3db504f3, v2
    v_mul_f32 v3, 0x3db504f3, v3
    v_mul_f32 v4, 0x3db504f3, v4
    v_mul_f32 v5, 0x3db504f3, v5
    v_cvt_pk_bf16_f32 v36, v2, v3
    v_cvt_pk_bf16_f32 v37, v4, v5
    v_lshlrev_b32 v2, 16, v36
    v_and_b32 v3, 0xffff0000, v36
    v_lshlrev_b32 v4, 16, v37
    v_and_b32 v5, 0xffff0000, v37
    v_max3_f32 v8, v2, v3, v8
    v_max3_f32 v8, v4, v5, v8
    s_waitcnt vmcnt(11)
    v_dot2_f32_bf16 v2, v108, v16, 0
    v_dot2_f32_bf16 v2, v109, v17, v2
    v_dot2_f32_bf16 v2, v110, v18, v2
    v_dot2_f32_bf16 v2, v111, v19, v2
    s_mov_b32 s72, 32768
    buffer_load_dwordx4 v[108:111], v9, s[4:7], s72 offen offset:0 nt
    s_waitcnt vmcnt(11)
    v_dot2_f32_bf16 v3, v112, v16, 0
    v_dot2_f32_bf16 v3, v113, v17, v3
    v_dot2_f32_bf16 v3, v114, v18, v3
    v_dot2_f32_bf16 v3, v115, v19, v3
    s_mov_b32 s72, 32768
    buffer_load_dwordx4 v[112:115], v9, s[4:7], s72 offen offset:1024 nt
    s_waitcnt vmcnt(11)
    v_dot2_f32_bf16 v4, v116, v16, 0
    v_dot2_f32_bf16 v4, v117, v17, v4
    v_dot2_f32_bf16 v4, v118, v18, v4
    v_dot2_f32_bf16 v4, v119, v19, v4
    s_mov_b32 s72, 32768
    buffer_load_dwordx4 v[116:119], v9, s[4:7], s72 offen offset:2048 nt
    s_waitcnt vmcnt(11)
    v_dot2_f32_bf16 v5, v120, v16, 0
    v_dot2_f32_bf16 v5, v121, v17, v5
    v_dot2_f32_bf16 v5, v122, v18, v5
    v_dot2_f32_bf16 v5, v123, v19, v5
    s_mov_b32 s72, 32768
    buffer_load_dwordx4 v[120:123], v9, s[4:7], s72 offen offset:3072 nt
    v_add_f32_dpp v2, v2, v2 row_ror:8 row_mask:0xf bank_mask:0xf
    v_add_f32_dpp v3, v3, v3 row_ror:8 row_mask:0xf bank_mask:0xf
    v_add_f32_dpp v4, v4, v4 row_ror:8 row_mask:0xf bank_mask:0xf
    v_add_f32_dpp v5, v5, v5 row_ror:8 row_mask:0xf bank_mask:0xf
    v_add_f32_dpp v2, v2, v2 row_ror:4 row_mask:0xf bank_mask:0xf
    v_add_f32_dpp v3, v3, v3 row_ror:4 row_mask:0xf bank_mask:0xf
    v_add_f32_dpp v4, v4, v4 row_ror:4 row_mask:0xf bank_mask:0xf
    v_add_f32_dpp v5, v5, v5 row_ror:4 row_mask:0xf bank_mask:0xf
    v_add_f32_dpp v2, v2, v2 row_ror:2 row_mask:0xf bank_mask:0xf
    v_add_f32_dpp v3, v3, v3 row_ror:2 row_mask:0xf bank_mask:0xf
    v_add_f32_dpp v4, v4, v4 row_ror:2 row_mask:0xf bank_mask:0xf
    v_add_f32_dpp v5, v5, v5 row_ror:2 row_mask:0xf bank_mask:0xf
    v_add_f32_dpp v2, v2, v2 row_ror:1 row_mask:0xf bank_mask:0xf
    v_add_f32_dpp v3, v3, v3 row_ror:1 row_mask:0xf bank_mask:0xf
    v_add_f32_dpp v4, v4, v4 row_ror:1 row_mask:0xf bank_mask:0xf
    v_add_f32_dpp v5, v5, v5 row_ror:1 row_mask:0xf bank_mask:0xf
    v_cvt_pk_bf16_f32 v6, v2, v3
    v_cvt_pk_bf16_f32 v7, v4, v5
    v_lshlrev_b32 v2, 16, v6
    v_and_b32 v3, 0xffff0000, v6
    v_lshlrev_b32 v4, 16, v7
    v_and_b32 v5, 0xffff0000, v7
    v_mul_f32 v2, 0x3db504f3, v2
    v_mul_f32 v3, 0x3db504f3, v3
    v_mul_f32 v4, 0x3db504f3, v4
    v_mul_f32 v5, 0x3db504f3, v5
    v_cvt_pk_bf16_f32 v38, v2, v3
    v_cvt_pk_bf16_f32 v39, v4, v5
    v_lshlrev_b32 v2, 16, v38
    v_and_b32 v3, 0xffff0000, v38
    v_lshlrev_b32 v4, 16, v39
    v_and_b32 v5, 0xffff0000, v39
    v_max3_f32 v8, v2, v3, v8
    v_max3_f32 v8, v4, v5, v8
    s_waitcnt vmcnt(11)
    v_dot2_f32_bf16 v2, v76, v16, 0
    v_dot2_f32_bf16 v2, v77, v17, v2
    v_dot2_f32_bf16 v2, v78, v18, v2
    v_dot2_f32_bf16 v2, v79, v19, v2
    s_mov_b32 s72, 36864
    buffer_load_dwordx4 v[76:79], v9, s[4:7], s72 offen offset:0 nt
    s_waitcnt vmcnt(11)
    v_dot2_f32_bf16 v3, v80, v16, 0
    v_dot2_f32_bf16 v3, v81, v17, v3
    v_dot2_f32_bf16 v3, v82, v18, v3
    v_dot2_f32_bf16 v3, v83, v19, v3
    s_mov_b32 s72, 36864
    buffer_load_dwordx4 v[80:83], v9, s[4:7], s72 offen offset:1024 nt
    s_waitcnt vmcnt(11)
    v_dot2_f32_bf16 v4, v84, v16, 0
    v_dot2_f32_bf16 v4, v85, v17, v4
    v_dot2_f32_bf16 v4, v86, v18, v4
    v_dot2_f32_bf16 v4, v87, v19, v4
    s_mov_b32 s72, 36864
    buffer_load_dwordx4 v[84:87], v9, s[4:7], s72 offen offset:2048 nt
    s_waitcnt vmcnt(11)
    v_dot2_f32_bf16 v5, v88, v16, 0
    v_dot2_f32_bf16 v5, v89, v17, v5
    v_dot2_f32_bf16 v5, v90, v18, v5
    v_dot2_f32_bf16 v5, v91, v19, v5
    s_mov_b32 s72, 36864
    buffer_load_dwordx4 v[88:91], v9, s[4:7], s72 offen offset:3072 nt
    v_add_f32_dpp v2, v2, v2 row_ror:8 row_mask:0xf bank_mask:0xf
    v_add_f32_dpp v3, v3, v3 row_ror:8 row_mask:0xf bank_mask:0xf
    v_add_f32_dpp v4, v4, v4 row_ror:8 row_mask:0xf bank_mask:0xf
    v_add_f32_dpp v5, v5, v5 row_ror:8 row_mask:0xf bank_mask:0xf
    v_add_f32_dpp v2, v2, v2 row_ror:4 row_mask:0xf bank_mask:0xf
    v_add_f32_dpp v3, v3, v3 row_ror:4 row_mask:0xf bank_mask:0xf
    v_add_f32_dpp v4, v4, v4 row_ror:4 row_mask:0xf bank_mask:0xf
    v_add_f32_dpp v5, v5, v5 row_ror:4 row_mask:0xf bank_mask:0xf
    v_add_f32_dpp v2, v2, v2 row_ror:2 row_mask:0xf bank_mask:0xf
    v_add_f32_dpp v3, v3, v3 row_ror:2 row_mask:0xf bank_mask:0xf
    v_add_f32_dpp v4, v4, v4 row_ror:2 row_mask:0xf bank_mask:0xf
    v_add_f32_dpp v5, v5, v5 row_ror:2 row_mask:0xf bank_mask:0xf
    v_add_f32_dpp v2, v2, v2 row_ror:1 row_mask:0xf bank_mask:0xf
    v_add_f32_dpp v3, v3, v3 row_ror:1 row_mask:0xf bank_mask:0xf
    v_add_f32_dpp v4, v4, v4 row_ror:1 row_mask:0xf bank_mask:0xf
    v_add_f32_dpp v5, v5, v5 row_ror:1 row_mask:0xf bank_mask:0xf
    v_cvt_pk_bf16_f32 v6, v2, v3
    v_cvt_pk_bf16_f32 v7, v4, v5
    v_lshlrev_b32 v2, 16, v6
    v_and_b32 v3, 0xffff0000, v6
    v_lshlrev_b32 v4, 16, v7
    v_and_b32 v5, 0xffff0000, v7
    v_mul_f32 v2, 0x3db504f3, v2
    v_mul_f32 v3, 0x3db504f3, v3
    v_mul_f32 v4, 0x3db504f3, v4
    v_mul_f32 v5, 0x3db504f3, v5
    v_cvt_pk_bf16_f32 v40, v2, v3
    v_cvt_pk_bf16_f32 v41, v4, v5
    v_lshlrev_b32 v2, 16, v40
    v_and_b32 v3, 0xffff0000, v40
    v_lshlrev_b32 v4, 16, v41
    v_and_b32 v5, 0xffff0000, v41
    v_max3_f32 v8, v2, v3, v8
    v_max3_f32 v8, v4, v5, v8
    s_waitcnt vmcnt(11)
    v_dot2_f32_bf16 v2, v92, v16, 0
    v_dot2_f32_bf16 v2, v93, v17, v2
    v_dot2_f32_bf16 v2, v94, v18, v2
    v_dot2_f32_bf16 v2, v95, v19, v2
    s_mov_b32 s72, 40960
    buffer_load_dwordx4 v[92:95], v9, s[4:7], s72 offen offset:0 nt
    s_waitcnt vmcnt(11)
    v_dot2_f32_bf16 v3, v96, v16, 0
    v_dot2_f32_bf16 v3, v97, v17, v3
    v_dot2_f32_bf16 v3, v98, v18, v3
    v_dot2_f32_bf16 v3, v99, v19, v3
    s_mov_b32 s72, 40960
    buffer_load_dwordx4 v[96:99], v9, s[4:7], s72 offen offset:1024 nt
    s_waitcnt vmcnt(11)
    v_dot2_f32_bf16 v4, v100, v16, 0
    v_dot2_f32_bf16 v4, v101, v17, v4
    v_dot2_f32_bf16 v4, v102, v18, v4
    v_dot2_f32_bf16 v4, v103, v19, v4
    s_mov_b32 s72, 40960
    buffer_load_dwordx4 v[100:103], v9, s[4:7], s72 offen offset:2048 nt
    s_waitcnt vmcnt(11)
    v_dot2_f32_bf16 v5, v104, v16, 0
    v_dot2_f32_bf16 v5, v105, v17, v5
    v_dot2_f32_bf16 v5, v106, v18, v5
    v_dot2_f32_bf16 v5, v107, v19, v5
    s_mov_b32 s72, 40960
    buffer_load_dwordx4 v[104:107], v9, s[4:7], s72 offen offset:3072 nt
    v_add_f32_dpp v2, v2, v2 row_ror:8 row_mask:0xf bank_mask:0xf
    v_add_f32_dpp v3, v3, v3 row_ror:8 row_mask:0xf bank_mask:0xf
    v_add_f32_dpp v4, v4, v4 row_ror:8 row_mask:0xf bank_mask:0xf
    v_add_f32_dpp v5, v5, v5 row_ror:8 row_mask:0xf bank_mask:0xf
    v_add_f32_dpp v2, v2, v2 row_ror:4 row_mask:0xf bank_mask:0xf
    v_add_f32_dpp v3, v3, v3 row_ror:4 row_mask:0xf bank_mask:0xf
    v_add_f32_dpp v4, v4, v4 row_ror:4 row_mask:0xf bank_mask:0xf
    v_add_f32_dpp v5, v5, v5 row_ror:4 row_mask:0xf bank_mask:0xf
    v_add_f32_dpp v2, v2, v2 row_ror:2 row_mask:0xf bank_mask:0xf
    v_add_f32_dpp v3, v3, v3 row_ror:2 row_mask:0xf bank_mask:0xf
    v_add_f32_dpp v4, v4, v4 row_ror:2 row_mask:0xf bank_mask:0xf
    v_add_f32_dpp v5, v5, v5 row_ror:2 row_mask:0xf bank_mask:0xf
    v_add_f32_dpp v2, v2, v2 row_ror:1 row_mask:0xf bank_mask:0xf
    v_add_f32_dpp v3, v3, v3 row_ror:1 row_mask:0xf bank_mask:0xf
    v_add_f32_dpp v4, v4, v4 row_ror:1 row_mask:0xf bank_mask:0xf
    v_add_f32_dpp v5, v5, v5 row_ror:1 row_mask:0xf bank_mask:0xf
    v_cvt_pk_bf16_f32 v6, v2, v3
    v_cvt_pk_bf16_f32 v7, v4, v5
    v_lshlrev_b32 v2, 16, v6
    v_and_b32 v3, 0xffff0000, v6
    v_lshlrev_b32 v4, 16, v7
    v_and_b32 v5, 0xffff0000, v7
    v_mul_f32 v2, 0x3db504f3, v2
    v_mul_f32 v3, 0x3db504f3, v3
    v_mul_f32 v4, 0x3db504f3, v4
    v_mul_f32 v5, 0x3db504f3, v5
    v_cvt_pk_bf16_f32 v42, v2, v3
    v_cvt_pk_bf16_f32 v43, v4, v5
    v_lshlrev_b32 v2, 16, v42
    v_and_b32 v3, 0xffff0000, v42
    v_lshlrev_b32 v4, 16, v43
    v_and_b32 v5, 0xffff0000, v43
    v_max3_f32 v8, v2, v3, v8
    v_max3_f32 v8, v4, v5, v8
    s_waitcnt vmcnt(32)
    v_lshlrev_b32 v6, 16, v44
    v_and_b32 v7, 0xffff0000, v44
    v_mul_f32 v10, s40, v6
    v_mul_f32 v11, s40, v7
    v_lshlrev_b32 v6, 16, v45
    v_and_b32 v7, 0xffff0000, v45
    v_fmac_f32 v10, s41, v6
    v_fmac_f32 v11, s41, v7
    v_lshlrev_b32 v6, 16, v46
    v_and_b32 v7, 0xffff0000, v46
    v_fmac_f32 v10, s42, v6
    v_fmac_f32 v11, s42, v7
    v_lshlrev_b32 v6, 16, v47
    v_and_b32 v7, 0xffff0000, v47
    v_fmac_f32 v10, s43, v6
    v_fmac_f32 v11, s43, v7
    v_lshlrev_b32 v6, 16, v48
    v_and_b32 v7, 0xffff0000, v48
    v_fmac_f32 v10, s44, v6
    v_fmac_f32 v11, s44, v7
    v_lshlrev_b32 v6, 16, v49
    v_and_b32 v7, 0xffff0000, v49
    v_fmac_f32 v10, s45, v6
    v_fmac_f32 v11, s45, v7
    v_lshlrev_b32 v6, 16, v50
    v_and_b32 v7, 0xffff0000, v50
    v_fmac_f32 v10, s46, v6
    v_fmac_f32 v11, s46, v7
    v_lshlrev_b32 v6, 16, v51
    v_and_b32 v7, 0xffff0000, v51
    v_fmac_f32 v10, s47, v6
    v_fmac_f32 v11, s47, v7
    v_lshlrev_b32 v6, 16, v52
    v_and_b32 v7, 0xffff0000, v52
    v_fmac_f32 v10, s48, v6
    v_fmac_f32 v11, s48, v7
    v_lshlrev_b32 v6, 16, v53
    v_and_b32 v7, 0xffff0000, v53
    v_fmac_f32 v10, s49, v6
    v_fmac_f32 v11, s49, v7
    v_lshlrev_b32 v6, 16, v54
    v_and_b32 v7, 0xffff0000, v54
    v_fmac_f32 v10, s50, v6
    v_fmac_f32 v11, s50, v7
    v_lshlrev_b32 v6, 16, v55
    v_and_b32 v7, 0xffff0000, v55
    v_fmac_f32 v10, s51, v6
    v_fmac_f32 v11, s51, v7
    v_lshlrev_b32 v6, 16, v56
    v_and_b32 v7, 0xffff0000, v56
    v_fmac_f32 v10, s52, v6
    v_fmac_f32 v11, s52, v7
    v_lshlrev_b32 v6, 16, v57
    v_and_b32 v7, 0xffff0000, v57
    v_fmac_f32 v10, s53, v6
    v_fmac_f32 v11, s53, v7
    v_lshlrev_b32 v6, 16, v58
    v_and_b32 v7, 0xffff0000, v58
    v_fmac_f32 v10, s54, v6
    v_fmac_f32 v11, s54, v7
    v_lshlrev_b32 v6, 16, v59
    v_and_b32 v7, 0xffff0000, v59
    v_fmac_f32 v10, s55, v6
    v_fmac_f32 v11, s55, v7
    v_lshlrev_b32 v6, 16, v60
    v_and_b32 v7, 0xffff0000, v60
    v_fmac_f32 v10, s56, v6
    v_fmac_f32 v11, s56, v7
    v_lshlrev_b32 v6, 16, v61
    v_and_b32 v7, 0xffff0000, v61
    v_fmac_f32 v10, s57, v6
    v_fmac_f32 v11, s57, v7
    v_lshlrev_b32 v6, 16, v62
    v_and_b32 v7, 0xffff0000, v62
    v_fmac_f32 v10, s58, v6
    v_fmac_f32 v11, s58, v7
    v_lshlrev_b32 v6, 16, v63
    v_and_b32 v7, 0xffff0000, v63
    v_fmac_f32 v10, s59, v6
    v_fmac_f32 v11, s59, v7
    v_lshlrev_b32 v6, 16, v64
    v_and_b32 v7, 0xffff0000, v64
    v_fmac_f32 v10, s60, v6
    v_fmac_f32 v11, s60, v7
    v_lshlrev_b32 v6, 16, v65
    v_and_b32 v7, 0xffff0000, v65
    v_fmac_f32 v10, s61, v6
    v_fmac_f32 v11, s61, v7
    v_lshlrev_b32 v6, 16, v66
    v_and_b32 v7, 0xffff0000, v66
    v_fmac_f32 v10, s62, v6
    v_fmac_f32 v11, s62, v7
    v_lshlrev_b32 v6, 16, v67
    v_and_b32 v7, 0xffff0000, v67
    v_fmac_f32 v10, s63, v6
    v_fmac_f32 v11, s63, v7
    v_lshlrev_b32 v6, 16, v68
    v_and_b32 v7, 0xffff0000, v68
    v_fmac_f32 v10, s64, v6
    v_fmac_f32 v11, s64, v7
    v_lshlrev_b32 v6, 16, v69
    v_and_b32 v7, 0xffff0000, v69
    v_fmac_f32 v10, s65, v6
    v_fmac_f32 v11, s65, v7
    v_lshlrev_b32 v6, 16, v70
    v_and_b32 v7, 0xffff0000, v70
    v_fmac_f32 v10, s66, v6
    v_fmac_f32 v11, s66, v7
    v_lshlrev_b32 v6, 16, v71
    v_and_b32 v7, 0xffff0000, v71
    v_fmac_f32 v10, s67, v6
    v_fmac_f32 v11, s67, v7
    v_lshlrev_b32 v6, 16, v72
    v_and_b32 v7, 0xffff0000, v72
    v_fmac_f32 v10, s68, v6
    v_fmac_f32 v11, s68, v7
    v_lshlrev_b32 v6, 16, v73
    v_and_b32 v7, 0xffff0000, v73
    v_fmac_f32 v10, s69, v6
    v_fmac_f32 v11, s69, v7
    v_lshlrev_b32 v6, 16, v74
    v_and_b32 v7, 0xffff0000, v74
    v_fmac_f32 v10, s70, v6
    v_fmac_f32 v11, s70, v7
    v_lshlrev_b32 v6, 16, v75
    v_and_b32 v7, 0xffff0000, v75
    v_fmac_f32 v10, s71, v6
    v_fmac_f32 v11, s71, v7
    s_lshl_b32 s15, s12, 9
    v_lshlrev_b32 v2, 3, v1
    v_add_u32 v2, s15, v2
    ds_write_b64 v2, v[10:11] offset:11264
    s_waitcnt vmcnt(11)
    v_dot2_f32_bf16 v2, v108, v16, 0
    v_dot2_f32_bf16 v2, v109, v17, v2
    v_dot2_f32_bf16 v2, v110, v18, v2
    v_dot2_f32_bf16 v2, v111, v19, v2
    s_mov_b32 s72, 45056
    buffer_load_dwordx4 v[108:111], v9, s[4:7], s72 offen offset:0 nt
    s_waitcnt vmcnt(11)
    v_dot2_f32_bf16 v3, v112, v16, 0
    v_dot2_f32_bf16 v3, v113, v17, v3
    v_dot2_f32_bf16 v3, v114, v18, v3
    v_dot2_f32_bf16 v3, v115, v19, v3
    s_mov_b32 s72, 45056
    buffer_load_dwordx4 v[112:115], v9, s[4:7], s72 offen offset:1024 nt
    s_waitcnt vmcnt(11)
    v_dot2_f32_bf16 v4, v116, v16, 0
    v_dot2_f32_bf16 v4, v117, v17, v4
    v_dot2_f32_bf16 v4, v118, v18, v4
    v_dot2_f32_bf16 v4, v119, v19, v4
    s_mov_b32 s72, 45056
    buffer_load_dwordx4 v[116:119], v9, s[4:7], s72 offen offset:2048 nt
    s_waitcnt vmcnt(11)
    v_dot2_f32_bf16 v5, v120, v16, 0
    v_dot2_f32_bf16 v5, v121, v17, v5
    v_dot2_f32_bf16 v5, v122, v18, v5
    v_dot2_f32_bf16 v5, v123, v19, v5
    s_mov_b32 s72, 45056
    buffer_load_dwordx4 v[120:123], v9, s[4:7], s72 offen offset:3072 nt
    v_add_f32_dpp v2, v2, v2 row_ror:8 row_mask:0xf bank_mask:0xf
    v_add_f32_dpp v3, v3, v3 row_ror:8 row_mask:0xf bank_mask:0xf
    v_add_f32_dpp v4, v4, v4 row_ror:8 row_mask:0xf bank_mask:0xf
    v_add_f32_dpp v5, v5, v5 row_ror:8 row_mask:0xf bank_mask:0xf
    v_add_f32_dpp v2, v2, v2 row_ror:4 row_mask:0xf bank_mask:0xf
    v_add_f32_dpp v3, v3, v3 row_ror:4 row_mask:0xf bank_mask:0xf
    v_add_f32_dpp v4, v4, v4 row_ror:4 row_mask:0xf bank_mask:0xf
    v_add_f32_dpp v5, v5, v5 row_ror:4 row_mask:0xf bank_mask:0xf
    v_add_f32_dpp v2, v2, v2 row_ror:2 row_mask:0xf bank_mask:0xf
    v_add_f32_dpp v3, v3, v3 row_ror:2 row_mask:0xf bank_mask:0xf
    v_add_f32_dpp v4, v4, v4 row_ror:2 row_mask:0xf bank_mask:0xf
    v_add_f32_dpp v5, v5, v5 row_ror:2 row_mask:0xf bank_mask:0xf
    v_add_f32_dpp v2, v2, v2 row_ror:1 row_mask:0xf bank_mask:0xf
    v_add_f32_dpp v3, v3, v3 row_ror:1 row_mask:0xf bank_mask:0xf
    v_add_f32_dpp v4, v4, v4 row_ror:1 row_mask:0xf bank_mask:0xf
    v_add_f32_dpp v5, v5, v5 row_ror:1 row_mask:0xf bank_mask:0xf
    v_cvt_pk_bf16_f32 v6, v2, v3
    v_cvt_pk_bf16_f32 v7, v4, v5
    v_lshlrev_b32 v2, 16, v6
    v_and_b32 v3, 0xffff0000, v6
    v_lshlrev_b32 v4, 16, v7
    v_and_b32 v5, 0xffff0000, v7
    v_mul_f32 v2, 0x3db504f3, v2
    v_mul_f32 v3, 0x3db504f3, v3
    v_mul_f32 v4, 0x3db504f3, v4
    v_mul_f32 v5, 0x3db504f3, v5
    v_cvt_pk_bf16_f32 v44, v2, v3
    v_cvt_pk_bf16_f32 v45, v4, v5
    v_lshlrev_b32 v2, 16, v44
    v_and_b32 v3, 0xffff0000, v44
    v_lshlrev_b32 v4, 16, v45
    v_and_b32 v5, 0xffff0000, v45
    v_max3_f32 v8, v2, v3, v8
    v_max3_f32 v8, v4, v5, v8
    s_waitcnt vmcnt(11)
    v_dot2_f32_bf16 v2, v76, v16, 0
    v_dot2_f32_bf16 v2, v77, v17, v2
    v_dot2_f32_bf16 v2, v78, v18, v2
    v_dot2_f32_bf16 v2, v79, v19, v2
    s_mov_b32 s72, 49152
    buffer_load_dwordx4 v[76:79], v9, s[4:7], s72 offen offset:0 nt
    s_waitcnt vmcnt(11)
    v_dot2_f32_bf16 v3, v80, v16, 0
    v_dot2_f32_bf16 v3, v81, v17, v3
    v_dot2_f32_bf16 v3, v82, v18, v3
    v_dot2_f32_bf16 v3, v83, v19, v3
    s_mov_b32 s72, 49152
    buffer_load_dwordx4 v[80:83], v9, s[4:7], s72 offen offset:1024 nt
    s_waitcnt vmcnt(11)
    v_dot2_f32_bf16 v4, v84, v16, 0
    v_dot2_f32_bf16 v4, v85, v17, v4
    v_dot2_f32_bf16 v4, v86, v18, v4
    v_dot2_f32_bf16 v4, v87, v19, v4
    s_mov_b32 s72, 49152
    buffer_load_dwordx4 v[84:87], v9, s[4:7], s72 offen offset:2048 nt
    s_waitcnt vmcnt(11)
    v_dot2_f32_bf16 v5, v88, v16, 0
    v_dot2_f32_bf16 v5, v89, v17, v5
    v_dot2_f32_bf16 v5, v90, v18, v5
    v_dot2_f32_bf16 v5, v91, v19, v5
    s_mov_b32 s72, 49152
    buffer_load_dwordx4 v[88:91], v9, s[4:7], s72 offen offset:3072 nt
    v_add_f32_dpp v2, v2, v2 row_ror:8 row_mask:0xf bank_mask:0xf
    v_add_f32_dpp v3, v3, v3 row_ror:8 row_mask:0xf bank_mask:0xf
    v_add_f32_dpp v4, v4, v4 row_ror:8 row_mask:0xf bank_mask:0xf
    v_add_f32_dpp v5, v5, v5 row_ror:8 row_mask:0xf bank_mask:0xf
    v_add_f32_dpp v2, v2, v2 row_ror:4 row_mask:0xf bank_mask:0xf
    v_add_f32_dpp v3, v3, v3 row_ror:4 row_mask:0xf bank_mask:0xf
    v_add_f32_dpp v4, v4, v4 row_ror:4 row_mask:0xf bank_mask:0xf
    v_add_f32_dpp v5, v5, v5 row_ror:4 row_mask:0xf bank_mask:0xf
    v_add_f32_dpp v2, v2, v2 row_ror:2 row_mask:0xf bank_mask:0xf
    v_add_f32_dpp v3, v3, v3 row_ror:2 row_mask:0xf bank_mask:0xf
    v_add_f32_dpp v4, v4, v4 row_ror:2 row_mask:0xf bank_mask:0xf
    v_add_f32_dpp v5, v5, v5 row_ror:2 row_mask:0xf bank_mask:0xf
    v_add_f32_dpp v2, v2, v2 row_ror:1 row_mask:0xf bank_mask:0xf
    v_add_f32_dpp v3, v3, v3 row_ror:1 row_mask:0xf bank_mask:0xf
    v_add_f32_dpp v4, v4, v4 row_ror:1 row_mask:0xf bank_mask:0xf
    v_add_f32_dpp v5, v5, v5 row_ror:1 row_mask:0xf bank_mask:0xf
    v_cvt_pk_bf16_f32 v6, v2, v3
    v_cvt_pk_bf16_f32 v7, v4, v5
    v_lshlrev_b32 v2, 16, v6
    v_and_b32 v3, 0xffff0000, v6
    v_lshlrev_b32 v4, 16, v7
    v_and_b32 v5, 0xffff0000, v7
    v_mul_f32 v2, 0x3db504f3, v2
    v_mul_f32 v3, 0x3db504f3, v3
    v_mul_f32 v4, 0x3db504f3, v4
    v_mul_f32 v5, 0x3db504f3, v5
    v_cvt_pk_bf16_f32 v46, v2, v3
    v_cvt_pk_bf16_f32 v47, v4, v5
    v_lshlrev_b32 v2, 16, v46
    v_and_b32 v3, 0xffff0000, v46
    v_lshlrev_b32 v4, 16, v47
    v_and_b32 v5, 0xffff0000, v47
    v_max3_f32 v8, v2, v3, v8
    v_max3_f32 v8, v4, v5, v8
    s_waitcnt vmcnt(11)
    v_dot2_f32_bf16 v2, v92, v16, 0
    v_dot2_f32_bf16 v2, v93, v17, v2
    v_dot2_f32_bf16 v2, v94, v18, v2
    v_dot2_f32_bf16 v2, v95, v19, v2
    s_mov_b32 s72, 53248
    buffer_load_dwordx4 v[92:95], v9, s[4:7], s72 offen offset:0 nt
    s_waitcnt vmcnt(11)
    v_dot2_f32_bf16 v3, v96, v16, 0
    v_dot2_f32_bf16 v3, v97, v17, v3
    v_dot2_f32_bf16 v3, v98, v18, v3
    v_dot2_f32_bf16 v3, v99, v19, v3
    s_mov_b32 s72, 53248
    buffer_load_dwordx4 v[96:99], v9, s[4:7], s72 offen offset:1024 nt
    s_waitcnt vmcnt(11)
    v_dot2_f32_bf16 v4, v100, v16, 0
    v_dot2_f32_bf16 v4, v101, v17, v4
    v_dot2_f32_bf16 v4, v102, v18, v4
    v_dot2_f32_bf16 v4, v103, v19, v4
    s_mov_b32 s72, 53248
    buffer_load_dwordx4 v[100:103], v9, s[4:7], s72 offen offset:2048 nt
    s_waitcnt vmcnt(11)
    v_dot2_f32_bf16 v5, v104, v16, 0
    v_dot2_f32_bf16 v5, v105, v17, v5
    v_dot2_f32_bf16 v5, v106, v18, v5
    v_dot2_f32_bf16 v5, v107, v19, v5
    s_mov_b32 s72, 53248
    buffer_load_dwordx4 v[104:107], v9, s[4:7], s72 offen offset:3072 nt
    v_add_f32_dpp v2, v2, v2 row_ror:8 row_mask:0xf bank_mask:0xf
    v_add_f32_dpp v3, v3, v3 row_ror:8 row_mask:0xf bank_mask:0xf
    v_add_f32_dpp v4, v4, v4 row_ror:8 row_mask:0xf bank_mask:0xf
    v_add_f32_dpp v5, v5, v5 row_ror:8 row_mask:0xf bank_mask:0xf
    v_add_f32_dpp v2, v2, v2 row_ror:4 row_mask:0xf bank_mask:0xf
    v_add_f32_dpp v3, v3, v3 row_ror:4 row_mask:0xf bank_mask:0xf
    v_add_f32_dpp v4, v4, v4 row_ror:4 row_mask:0xf bank_mask:0xf
    v_add_f32_dpp v5, v5, v5 row_ror:4 row_mask:0xf bank_mask:0xf
    v_add_f32_dpp v2, v2, v2 row_ror:2 row_mask:0xf bank_mask:0xf
    v_add_f32_dpp v3, v3, v3 row_ror:2 row_mask:0xf bank_mask:0xf
    v_add_f32_dpp v4, v4, v4 row_ror:2 row_mask:0xf bank_mask:0xf
    v_add_f32_dpp v5, v5, v5 row_ror:2 row_mask:0xf bank_mask:0xf
    v_add_f32_dpp v2, v2, v2 row_ror:1 row_mask:0xf bank_mask:0xf
    v_add_f32_dpp v3, v3, v3 row_ror:1 row_mask:0xf bank_mask:0xf
    v_add_f32_dpp v4, v4, v4 row_ror:1 row_mask:0xf bank_mask:0xf
    v_add_f32_dpp v5, v5, v5 row_ror:1 row_mask:0xf bank_mask:0xf
    v_cvt_pk_bf16_f32 v6, v2, v3
    v_cvt_pk_bf16_f32 v7, v4, v5
    v_lshlrev_b32 v2, 16, v6
    v_and_b32 v3, 0xffff0000, v6
    v_lshlrev_b32 v4, 16, v7
    v_and_b32 v5, 0xffff0000, v7
    v_mul_f32 v2, 0x3db504f3, v2
    v_mul_f32 v3, 0x3db504f3, v3
    v_mul_f32 v4, 0x3db504f3, v4
    v_mul_f32 v5, 0x3db504f3, v5
    v_cvt_pk_bf16_f32 v48, v2, v3
    v_cvt_pk_bf16_f32 v49, v4, v5
    v_lshlrev_b32 v2, 16, v48
    v_and_b32 v3, 0xffff0000, v48
    v_lshlrev_b32 v4, 16, v49
    v_and_b32 v5, 0xffff0000, v49
    v_max3_f32 v8, v2, v3, v8
    v_max3_f32 v8, v4, v5, v8
    s_waitcnt vmcnt(11)
    v_dot2_f32_bf16 v2, v108, v16, 0
    v_dot2_f32_bf16 v2, v109, v17, v2
    v_dot2_f32_bf16 v2, v110, v18, v2
    v_dot2_f32_bf16 v2, v111, v19, v2
    s_mov_b32 s72, 57344
    buffer_load_dwordx4 v[108:111], v9, s[4:7], s72 offen offset:0 nt
    s_waitcnt vmcnt(11)
    v_dot2_f32_bf16 v3, v112, v16, 0
    v_dot2_f32_bf16 v3, v113, v17, v3
    v_dot2_f32_bf16 v3, v114, v18, v3
    v_dot2_f32_bf16 v3, v115, v19, v3
    s_mov_b32 s72, 57344
    buffer_load_dwordx4 v[112:115], v9, s[4:7], s72 offen offset:1024 nt
    s_waitcnt vmcnt(11)
    v_dot2_f32_bf16 v4, v116, v16, 0
    v_dot2_f32_bf16 v4, v117, v17, v4
    v_dot2_f32_bf16 v4, v118, v18, v4
    v_dot2_f32_bf16 v4, v119, v19, v4
    s_mov_b32 s72, 57344
    buffer_load_dwordx4 v[116:119], v9, s[4:7], s72 offen offset:2048 nt
    s_waitcnt vmcnt(11)
    v_dot2_f32_bf16 v5, v120, v16, 0
    v_dot2_f32_bf16 v5, v121, v17, v5
    v_dot2_f32_bf16 v5, v122, v18, v5
    v_dot2_f32_bf16 v5, v123, v19, v5
    s_mov_b32 s72, 57344
    buffer_load_dwordx4 v[120:123], v9, s[4:7], s72 offen offset:3072 nt
    v_add_f32_dpp v2, v2, v2 row_ror:8 row_mask:0xf bank_mask:0xf
    v_add_f32_dpp v3, v3, v3 row_ror:8 row_mask:0xf bank_mask:0xf
    v_add_f32_dpp v4, v4, v4 row_ror:8 row_mask:0xf bank_mask:0xf
    v_add_f32_dpp v5, v5, v5 row_ror:8 row_mask:0xf bank_mask:0xf
    v_add_f32_dpp v2, v2, v2 row_ror:4 row_mask:0xf bank_mask:0xf
    v_add_f32_dpp v3, v3, v3 row_ror:4 row_mask:0xf bank_mask:0xf
    v_add_f32_dpp v4, v4, v4 row_ror:4 row_mask:0xf bank_mask:0xf
    v_add_f32_dpp v5, v5, v5 row_ror:4 row_mask:0xf bank_mask:0xf
    v_add_f32_dpp v2, v2, v2 row_ror:2 row_mask:0xf bank_mask:0xf
    v_add_f32_dpp v3, v3, v3 row_ror:2 row_mask:0xf bank_mask:0xf
    v_add_f32_dpp v4, v4, v4 row_ror:2 row_mask:0xf bank_mask:0xf
    v_add_f32_dpp v5, v5, v5 row_ror:2 row_mask:0xf bank_mask:0xf
    v_add_f32_dpp v2, v2, v2 row_ror:1 row_mask:0xf bank_mask:0xf
    v_add_f32_dpp v3, v3, v3 row_ror:1 row_mask:0xf bank_mask:0xf
    v_add_f32_dpp v4, v4, v4 row_ror:1 row_mask:0xf bank_mask:0xf
    v_add_f32_dpp v5, v5, v5 row_ror:1 row_mask:0xf bank_mask:0xf
    v_cvt_pk_bf16_f32 v6, v2, v3
    v_cvt_pk_bf16_f32 v7, v4, v5
    v_lshlrev_b32 v2, 16, v6
    v_and_b32 v3, 0xffff0000, v6
    v_lshlrev_b32 v4, 16, v7
    v_and_b32 v5, 0xffff0000, v7
    v_mul_f32 v2, 0x3db504f3, v2
    v_mul_f32 v3, 0x3db504f3, v3
    v_mul_f32 v4, 0x3db504f3, v4
    v_mul_f32 v5, 0x3db504f3, v5
    v_cvt_pk_bf16_f32 v50, v2, v3
    v_cvt_pk_bf16_f32 v51, v4, v5
    v_lshlrev_b32 v2, 16, v50
    v_and_b32 v3, 0xffff0000, v50
    v_lshlrev_b32 v4, 16, v51
    v_and_b32 v5, 0xffff0000, v51
    v_max3_f32 v8, v2, v3, v8
    v_max3_f32 v8, v4, v5, v8
    s_waitcnt vmcnt(11)
    v_dot2_f32_bf16 v2, v76, v16, 0
    v_dot2_f32_bf16 v2, v77, v17, v2
    v_dot2_f32_bf16 v2, v78, v18, v2
    v_dot2_f32_bf16 v2, v79, v19, v2
    s_mov_b32 s72, 61440
    buffer_load_dwordx4 v[76:79], v9, s[4:7], s72 offen offset:0 nt
    s_waitcnt vmcnt(11)
    v_dot2_f32_bf16 v3, v80, v16, 0
    v_dot2_f32_bf16 v3, v81, v17, v3
    v_dot2_f32_bf16 v3, v82, v18, v3
    v_dot2_f32_bf16 v3, v83, v19, v3
    s_mov_b32 s72, 61440
    buffer_load_dwordx4 v[80:83], v9, s[4:7], s72 offen offset:1024 nt
    s_waitcnt vmcnt(11)
    v_dot2_f32_bf16 v4, v84, v16, 0
    v_dot2_f32_bf16 v4, v85, v17, v4
    v_dot2_f32_bf16 v4, v86, v18, v4
    v_dot2_f32_bf16 v4, v87, v19, v4
    s_mov_b32 s72, 61440
    buffer_load_dwordx4 v[84:87], v9, s[4:7], s72 offen offset:2048 nt
    s_waitcnt vmcnt(11)
    v_dot2_f32_bf16 v5, v88, v16, 0
    v_dot2_f32_bf16 v5, v89, v17, v5
    v_dot2_f32_bf16 v5, v90, v18, v5
    v_dot2_f32_bf16 v5, v91, v19, v5
    s_mov_b32 s72, 61440
    buffer_load_dwordx4 v[88:91], v9, s[4:7], s72 offen offset:3072 nt
    v_add_f32_dpp v2, v2, v2 row_ror:8 row_mask:0xf bank_mask:0xf
    v_add_f32_dpp v3, v3, v3 row_ror:8 row_mask:0xf bank_mask:0xf
    v_add_f32_dpp v4, v4, v4 row_ror:8 row_mask:0xf bank_mask:0xf
    v_add_f32_dpp v5, v5, v5 row_ror:8 row_mask:0xf bank_mask:0xf
    v_add_f32_dpp v2, v2, v2 row_ror:4 row_mask:0xf bank_mask:0xf
    v_add_f32_dpp v3, v3, v3 row_ror:4 row_mask:0xf bank_mask:0xf
    v_add_f32_dpp v4, v4, v4 row_ror:4 row_mask:0xf bank_mask:0xf
    v_add_f32_dpp v5, v5, v5 row_ror:4 row_mask:0xf bank_mask:0xf
    v_add_f32_dpp v2, v2, v2 row_ror:2 row_mask:0xf bank_mask:0xf
    v_add_f32_dpp v3, v3, v3 row_ror:2 row_mask:0xf bank_mask:0xf
    v_add_f32_dpp v4, v4, v4 row_ror:2 row_mask:0xf bank_mask:0xf
    v_add_f32_dpp v5, v5, v5 row_ror:2 row_mask:0xf bank_mask:0xf
    v_add_f32_dpp v2, v2, v2 row_ror:1 row_mask:0xf bank_mask:0xf
    v_add_f32_dpp v3, v3, v3 row_ror:1 row_mask:0xf bank_mask:0xf
    v_add_f32_dpp v4, v4, v4 row_ror:1 row_mask:0xf bank_mask:0xf
    v_add_f32_dpp v5, v5, v5 row_ror:1 row_mask:0xf bank_mask:0xf
    v_cvt_pk_bf16_f32 v6, v2, v3
    v_cvt_pk_bf16_f32 v7, v4, v5
    v_lshlrev_b32 v2, 16, v6
    v_and_b32 v3, 0xffff0000, v6
    v_lshlrev_b32 v4, 16, v7
    v_and_b32 v5, 0xffff0000, v7
    v_mul_f32 v2, 0x3db504f3, v2
    v_mul_f32 v3, 0x3db504f3, v3
    v_mul_f32 v4, 0x3db504f3, v4
    v_mul_f32 v5, 0x3db504f3, v5
    v_cvt_pk_bf16_f32 v52, v2, v3
    v_cvt_pk_bf16_f32 v53, v4, v5
    v_lshlrev_b32 v2, 16, v52
    v_and_b32 v3, 0xffff0000, v52
    v_lshlrev_b32 v4, 16, v53
    v_and_b32 v5, 0xffff0000, v53
    v_max3_f32 v8, v2, v3, v8
    v_max3_f32 v8, v4, v5, v8
    s_waitcnt vmcnt(11)
    v_dot2_f32_bf16 v2, v92, v16, 0
    v_dot2_f32_bf16 v2, v93, v17, v2
    v_dot2_f32_bf16 v2, v94, v18, v2
    v_dot2_f32_bf16 v2, v95, v19, v2
    s_mov_b32 s72, 0
    buffer_load_dwordx4 v[92:95], v9, s[8:11], s72 offen offset:0 nt
    s_waitcnt vmcnt(11)
    v_dot2_f32_bf16 v3, v96, v16, 0
    v_dot2_f32_bf16 v3, v97, v17, v3
    v_dot2_f32_bf16 v3, v98, v18, v3
    v_dot2_f32_bf16 v3, v99, v19, v3
    s_mov_b32 s72, 0
    buffer_load_dwordx4 v[96:99], v9, s[8:11], s72 offen offset:1024 nt
    s_waitcnt vmcnt(11)
    v_dot2_f32_bf16 v4, v100, v16, 0
    v_dot2_f32_bf16 v4, v101, v17, v4
    v_dot2_f32_bf16 v4, v102, v18, v4
    v_dot2_f32_bf16 v4, v103, v19, v4
    s_mov_b32 s72, 0
    buffer_load_dwordx4 v[100:103], v9, s[8:11], s72 offen offset:2048 nt
    s_waitcnt vmcnt(11)
    v_dot2_f32_bf16 v5, v104, v16, 0
    v_dot2_f32_bf16 v5, v105, v17, v5
    v_dot2_f32_bf16 v5, v106, v18, v5
    v_dot2_f32_bf16 v5, v107, v19, v5
    s_mov_b32 s72, 0
    buffer_load_dwordx4 v[104:107], v9, s[8:11], s72 offen offset:3072 nt
    v_add_f32_dpp v2, v2, v2 row_ror:8 row_mask:0xf bank_mask:0xf
    v_add_f32_dpp v3, v3, v3 row_ror:8 row_mask:0xf bank_mask:0xf
    v_add_f32_dpp v4, v4, v4 row_ror:8 row_mask:0xf bank_mask:0xf
    v_add_f32_dpp v5, v5, v5 row_ror:8 row_mask:0xf bank_mask:0xf
    v_add_f32_dpp v2, v2, v2 row_ror:4 row_mask:0xf bank_mask:0xf
    v_add_f32_dpp v3, v3, v3 row_ror:4 row_mask:0xf bank_mask:0xf
    v_add_f32_dpp v4, v4, v4 row_ror:4 row_mask:0xf bank_mask:0xf
    v_add_f32_dpp v5, v5, v5 row_ror:4 row_mask:0xf bank_mask:0xf
    v_add_f32_dpp v2, v2, v2 row_ror:2 row_mask:0xf bank_mask:0xf
    v_add_f32_dpp v3, v3, v3 row_ror:2 row_mask:0xf bank_mask:0xf
    v_add_f32_dpp v4, v4, v4 row_ror:2 row_mask:0xf bank_mask:0xf
    v_add_f32_dpp v5, v5, v5 row_ror:2 row_mask:0xf bank_mask:0xf
    v_add_f32_dpp v2, v2, v2 row_ror:1 row_mask:0xf bank_mask:0xf
    v_add_f32_dpp v3, v3, v3 row_ror:1 row_mask:0xf bank_mask:0xf
    v_add_f32_dpp v4, v4, v4 row_ror:1 row_mask:0xf bank_mask:0xf
    v_add_f32_dpp v5, v5, v5 row_ror:1 row_mask:0xf bank_mask:0xf
    v_cvt_pk_bf16_f32 v6, v2, v3
    v_cvt_pk_bf16_f32 v7, v4, v5
    v_lshlrev_b32 v2, 16, v6
    v_and_b32 v3, 0xffff0000, v6
    v_lshlrev_b32 v4, 16, v7
    v_and_b32 v5, 0xffff0000, v7
    v_mul_f32 v2, 0x3db504f3, v2
    v_mul_f32 v3, 0x3db504f3, v3
    v_mul_f32 v4, 0x3db504f3, v4
    v_mul_f32 v5, 0x3db504f3, v5
    v_cvt_pk_bf16_f32 v54, v2, v3
    v_cvt_pk_bf16_f32 v55, v4, v5
    v_lshlrev_b32 v2, 16, v54
    v_and_b32 v3, 0xffff0000, v54
    v_lshlrev_b32 v4, 16, v55
    v_and_b32 v5, 0xffff0000, v55
    v_max3_f32 v8, v2, v3, v8
    v_max3_f32 v8, v4, v5, v8
    s_waitcnt vmcnt(11)
    v_dot2_f32_bf16 v2, v108, v16, 0
    v_dot2_f32_bf16 v2, v109, v17, v2
    v_dot2_f32_bf16 v2, v110, v18, v2
    v_dot2_f32_bf16 v2, v111, v19, v2
    s_mov_b32 s72, 4096
    buffer_load_dwordx4 v[108:111], v9, s[8:11], s72 offen offset:0 nt
    s_waitcnt vmcnt(11)
    v_dot2_f32_bf16 v3, v112, v16, 0
    v_dot2_f32_bf16 v3, v113, v17, v3
    v_dot2_f32_bf16 v3, v114, v18, v3
    v_dot2_f32_bf16 v3, v115, v19, v3
    s_mov_b32 s72, 4096
    buffer_load_dwordx4 v[112:115], v9, s[8:11], s72 offen offset:1024 nt
    s_waitcnt vmcnt(11)
    v_dot2_f32_bf16 v4, v116, v16, 0
    v_dot2_f32_bf16 v4, v117, v17, v4
    v_dot2_f32_bf16 v4, v118, v18, v4
    v_dot2_f32_bf16 v4, v119, v19, v4
    s_mov_b32 s72, 4096
    buffer_load_dwordx4 v[116:119], v9, s[8:11], s72 offen offset:2048 nt
    s_waitcnt vmcnt(11)
    v_dot2_f32_bf16 v5, v120, v16, 0
    v_dot2_f32_bf16 v5, v121, v17, v5
    v_dot2_f32_bf16 v5, v122, v18, v5
    v_dot2_f32_bf16 v5, v123, v19, v5
    s_mov_b32 s72, 4096
    buffer_load_dwordx4 v[120:123], v9, s[8:11], s72 offen offset:3072 nt
    v_add_f32_dpp v2, v2, v2 row_ror:8 row_mask:0xf bank_mask:0xf
    v_add_f32_dpp v3, v3, v3 row_ror:8 row_mask:0xf bank_mask:0xf
    v_add_f32_dpp v4, v4, v4 row_ror:8 row_mask:0xf bank_mask:0xf
    v_add_f32_dpp v5, v5, v5 row_ror:8 row_mask:0xf bank_mask:0xf
    v_add_f32_dpp v2, v2, v2 row_ror:4 row_mask:0xf bank_mask:0xf
    v_add_f32_dpp v3, v3, v3 row_ror:4 row_mask:0xf bank_mask:0xf
    v_add_f32_dpp v4, v4, v4 row_ror:4 row_mask:0xf bank_mask:0xf
    v_add_f32_dpp v5, v5, v5 row_ror:4 row_mask:0xf bank_mask:0xf
    v_add_f32_dpp v2, v2, v2 row_ror:2 row_mask:0xf bank_mask:0xf
    v_add_f32_dpp v3, v3, v3 row_ror:2 row_mask:0xf bank_mask:0xf
    v_add_f32_dpp v4, v4, v4 row_ror:2 row_mask:0xf bank_mask:0xf
    v_add_f32_dpp v5, v5, v5 row_ror:2 row_mask:0xf bank_mask:0xf
    v_add_f32_dpp v2, v2, v2 row_ror:1 row_mask:0xf bank_mask:0xf
    v_add_f32_dpp v3, v3, v3 row_ror:1 row_mask:0xf bank_mask:0xf
    v_add_f32_dpp v4, v4, v4 row_ror:1 row_mask:0xf bank_mask:0xf
    v_add_f32_dpp v5, v5, v5 row_ror:1 row_mask:0xf bank_mask:0xf
    v_cvt_pk_bf16_f32 v6, v2, v3
    v_cvt_pk_bf16_f32 v7, v4, v5
    v_lshlrev_b32 v2, 16, v6
    v_and_b32 v3, 0xffff0000, v6
    v_lshlrev_b32 v4, 16, v7
    v_and_b32 v5, 0xffff0000, v7
    v_mul_f32 v2, 0x3db504f3, v2
    v_mul_f32 v3, 0x3db504f3, v3
    v_mul_f32 v4, 0x3db504f3, v4
    v_mul_f32 v5, 0x3db504f3, v5
    v_cvt_pk_bf16_f32 v56, v2, v3
    v_cvt_pk_bf16_f32 v57, v4, v5
    v_lshlrev_b32 v2, 16, v56
    v_and_b32 v3, 0xffff0000, v56
    v_lshlrev_b32 v4, 16, v57
    v_and_b32 v5, 0xffff0000, v57
    v_max3_f32 v8, v2, v3, v8
    v_max3_f32 v8, v4, v5, v8
    s_waitcnt vmcnt(11)
    v_dot2_f32_bf16 v2, v76, v16, 0
    v_dot2_f32_bf16 v2, v77, v17, v2
    v_dot2_f32_bf16 v2, v78, v18, v2
    v_dot2_f32_bf16 v2, v79, v19, v2
    s_mov_b32 s72, 8192
    buffer_load_dwordx4 v[76:79], v9, s[8:11], s72 offen offset:0 nt
    s_waitcnt vmcnt(11)
    v_dot2_f32_bf16 v3, v80, v16, 0
    v_dot2_f32_bf16 v3, v81, v17, v3
    v_dot2_f32_bf16 v3, v82, v18, v3
    v_dot2_f32_bf16 v3, v83, v19, v3
    s_mov_b32 s72, 8192
    buffer_load_dwordx4 v[80:83], v9, s[8:11], s72 offen offset:1024 nt
    s_waitcnt vmcnt(11)
    v_dot2_f32_bf16 v4, v84, v16, 0
    v_dot2_f32_bf16 v4, v85, v17, v4
    v_dot2_f32_bf16 v4, v86, v18, v4
    v_dot2_f32_bf16 v4, v87, v19, v4
    s_mov_b32 s72, 8192
    buffer_load_dwordx4 v[84:87], v9, s[8:11], s72 offen offset:2048 nt
    s_waitcnt vmcnt(11)
    v_dot2_f32_bf16 v5, v88, v16, 0
    v_dot2_f32_bf16 v5, v89, v17, v5
    v_dot2_f32_bf16 v5, v90, v18, v5
    v_dot2_f32_bf16 v5, v91, v19, v5
    s_mov_b32 s72, 8192
    buffer_load_dwordx4 v[88:91], v9, s[8:11], s72 offen offset:3072 nt
    v_add_f32_dpp v2, v2, v2 row_ror:8 row_mask:0xf bank_mask:0xf
    v_add_f32_dpp v3, v3, v3 row_ror:8 row_mask:0xf bank_mask:0xf
    v_add_f32_dpp v4, v4, v4 row_ror:8 row_mask:0xf bank_mask:0xf
    v_add_f32_dpp v5, v5, v5 row_ror:8 row_mask:0xf bank_mask:0xf
    v_add_f32_dpp v2, v2, v2 row_ror:4 row_mask:0xf bank_mask:0xf
    v_add_f32_dpp v3, v3, v3 row_ror:4 row_mask:0xf bank_mask:0xf
    v_add_f32_dpp v4, v4, v4 row_ror:4 row_mask:0xf bank_mask:0xf
    v_add_f32_dpp v5, v5, v5 row_ror:4 row_mask:0xf bank_mask:0xf
    v_add_f32_dpp v2, v2, v2 row_ror:2 row_mask:0xf bank_mask:0xf
    v_add_f32_dpp v3, v3, v3 row_ror:2 row_mask:0xf bank_mask:0xf
    v_add_f32_dpp v4, v4, v4 row_ror:2 row_mask:0xf bank_mask:0xf
    v_add_f32_dpp v5, v5, v5 row_ror:2 row_mask:0xf bank_mask:0xf
    v_add_f32_dpp v2, v2, v2 row_ror:1 row_mask:0xf bank_mask:0xf
    v_add_f32_dpp v3, v3, v3 row_ror:1 row_mask:0xf bank_mask:0xf
    v_add_f32_dpp v4, v4, v4 row_ror:1 row_mask:0xf bank_mask:0xf
    v_add_f32_dpp v5, v5, v5 row_ror:1 row_mask:0xf bank_mask:0xf
    v_cvt_pk_bf16_f32 v6, v2, v3
    v_cvt_pk_bf16_f32 v7, v4, v5
    v_lshlrev_b32 v2, 16, v6
    v_and_b32 v3, 0xffff0000, v6
    v_lshlrev_b32 v4, 16, v7
    v_and_b32 v5, 0xffff0000, v7
    v_mul_f32 v2, 0x3db504f3, v2
    v_mul_f32 v3, 0x3db504f3, v3
    v_mul_f32 v4, 0x3db504f3, v4
    v_mul_f32 v5, 0x3db504f3, v5
    v_cvt_pk_bf16_f32 v58, v2, v3
    v_cvt_pk_bf16_f32 v59, v4, v5
    v_lshlrev_b32 v2, 16, v58
    v_and_b32 v3, 0xffff0000, v58
    v_lshlrev_b32 v4, 16, v59
    v_and_b32 v5, 0xffff0000, v59
    v_max3_f32 v8, v2, v3, v8
    v_max3_f32 v8, v4, v5, v8
    s_nop 1
    v_readlane_b32 s40, v8, 0
    v_readlane_b32 s41, v8, 16
    v_readlane_b32 s42, v8, 32
    v_readlane_b32 s43, v8, 48
    s_nop 1
    v_mov_b32 v8, s40
    v_max_f32 v8, s41, v8
    v_max_f32 v8, s42, v8
    v_max_f32 v8, s43, v8
    v_mul_f32 v15, s76, v8
    v_sub_f32 v15, 0, v15
    v_mov_b32 v6, 0
    v_lshlrev_b32 v2, 16, v28
    v_and_b32 v3, 0xffff0000, v28
    v_fma_f32 v2, v2, s76, v15
    v_fma_f32 v3, v3, s76, v15
    v_exp_f32 v2, v2
    v_exp_f32 v3, v3
    s_nop 0
    v_add_f32 v6, v6, v2
    v_add_f32 v6, v6, v3
    v_lshlrev_b32 v2, 16, v29
    v_and_b32 v3, 0xffff0000, v29
    v_fma_f32 v2, v2, s76, v15
    v_fma_f32 v3, v3, s76, v15
    v_exp_f32 v2, v2
    v_exp_f32 v3, v3
    s_nop 0
    v_add_f32 v6, v6, v2
    v_add_f32 v6, v6, v3
    v_lshlrev_b32 v2, 16, v30
    v_and_b32 v3, 0xffff0000, v30
    v_fma_f32 v2, v2, s76, v15
    v_fma_f32 v3, v3, s76, v15
    v_exp_f32 v2, v2
    v_exp_f32 v3, v3
    s_nop 0
    v_add_f32 v6, v6, v2
    v_add_f32 v6, v6, v3
    v_lshlrev_b32 v2, 16, v31
    v_and_b32 v3, 0xffff0000, v31
    v_fma_f32 v2, v2, s76, v15
    v_fma_f32 v3, v3, s76, v15
    v_exp_f32 v2, v2
    v_exp_f32 v3, v3
    s_nop 0
    v_add_f32 v6, v6, v2
    v_add_f32 v6, v6, v3
    v_lshlrev_b32 v2, 16, v32
    v_and_b32 v3, 0xffff0000, v32
    v_fma_f32 v2, v2, s76, v15
    v_fma_f32 v3, v3, s76, v15
    v_exp_f32 v2, v2
    v_exp_f32 v3, v3
    s_nop 0
    v_add_f32 v6, v6, v2
    v_add_f32 v6, v6, v3
    v_lshlrev_b32 v2, 16, v33
    v_and_b32 v3, 0xffff0000, v33
    v_fma_f32 v2, v2, s76, v15
    v_fma_f32 v3, v3, s76, v15
    v_exp_f32 v2, v2
    v_exp_f32 v3, v3
    s_nop 0
    v_add_f32 v6, v6, v2
    v_add_f32 v6, v6, v3
    v_lshlrev_b32 v2, 16, v34
    v_and_b32 v3, 0xffff0000, v34
    v_fma_f32 v2, v2, s76, v15
    v_fma_f32 v3, v3, s76, v15
    v_exp_f32 v2, v2
    v_exp_f32 v3, v3
    s_nop 0
    v_add_f32 v6, v6, v2
    v_add_f32 v6, v6, v3
    v_lshlrev_b32 v2, 16, v35
    v_and_b32 v3, 0xffff0000, v35
    v_fma_f32 v2, v2, s76, v15
    v_fma_f32 v3, v3, s76, v15
    v_exp_f32 v2, v2
    v_exp_f32 v3, v3
    s_nop 0
    v_add_f32 v6, v6, v2
    v_add_f32 v6, v6, v3
    v_lshlrev_b32 v2, 16, v36
    v_and_b32 v3, 0xffff0000, v36
    v_fma_f32 v2, v2, s76, v15
    v_fma_f32 v3, v3, s76, v15
    v_exp_f32 v2, v2
    v_exp_f32 v3, v3
    s_nop 0
    v_add_f32 v6, v6, v2
    v_add_f32 v6, v6, v3
    v_lshlrev_b32 v2, 16, v37
    v_and_b32 v3, 0xffff0000, v37
    v_fma_f32 v2, v2, s76, v15
    v_fma_f32 v3, v3, s76, v15
    v_exp_f32 v2, v2
    v_exp_f32 v3, v3
    s_nop 0
    v_add_f32 v6, v6, v2
    v_add_f32 v6, v6, v3
    v_lshlrev_b32 v2, 16, v38
    v_and_b32 v3, 0xffff0000, v38
    v_fma_f32 v2, v2, s76, v15
    v_fma_f32 v3, v3, s76, v15
    v_exp_f32 v2, v2
    v_exp_f32 v3, v3
    s_nop 0
    v_add_f32 v6, v6, v2
    v_add_f32 v6, v6, v3
    v_lshlrev_b32 v2, 16, v39
    v_and_b32 v3, 0xffff0000, v39
    v_fma_f32 v2, v2, s76, v15
    v_fma_f32 v3, v3, s76, v15
    v_exp_f32 v2, v2
    v_exp_f32 v3, v3
    s_nop 0
    v_add_f32 v6, v6, v2
    v_add_f32 v6, v6, v3
    v_lshlrev_b32 v2, 16, v40
    v_and_b32 v3, 0xffff0000, v40
    v_fma_f32 v2, v2, s76, v15
    v_fma_f32 v3, v3, s76, v15
    v_exp_f32 v2, v2
    v_exp_f32 v3, v3
    s_nop 0
    v_add_f32 v6, v6, v2
    v_add_f32 v6, v6, v3
    v_lshlrev_b32 v2, 16, v41
    v_and_b32 v3, 0xffff0000, v41
    v_fma_f32 v2, v2, s76, v15
    v_fma_f32 v3, v3, s76, v15
    v_exp_f32 v2, v2
    v_exp_f32 v3, v3
    s_nop 0
    v_add_f32 v6, v6, v2
    v_add_f32 v6, v6, v3
    v_lshlrev_b32 v2, 16, v42
    v_and_b32 v3, 0xffff0000, v42
    v_fma_f32 v2, v2, s76, v15
    v_fma_f32 v3, v3, s76, v15
    v_exp_f32 v2, v2
    v_exp_f32 v3, v3
    s_nop 0
    v_add_f32 v6, v6, v2
    v_add_f32 v6, v6, v3
    v_lshlrev_b32 v2, 16, v43
    v_and_b32 v3, 0xffff0000, v43
    v_fma_f32 v2, v2, s76, v15
    v_fma_f32 v3, v3, s76, v15
    v_exp_f32 v2, v2
    v_exp_f32 v3, v3
    s_nop 0
    v_add_f32 v6, v6, v2
    v_add_f32 v6, v6, v3
    v_lshlrev_b32 v2, 16, v44
    v_and_b32 v3, 0xffff0000, v44
    v_fma_f32 v2, v2, s76, v15
    v_fma_f32 v3, v3, s76, v15
    v_exp_f32 v2, v2
    v_exp_f32 v3, v3
    s_nop 0
    v_add_f32 v6, v6, v2
    v_add_f32 v6, v6, v3
    v_lshlrev_b32 v2, 16, v45
    v_and_b32 v3, 0xffff0000, v45
    v_fma_f32 v2, v2, s76, v15
    v_fma_f32 v3, v3, s76, v15
    v_exp_f32 v2, v2
    v_exp_f32 v3, v3
    s_nop 0
    v_add_f32 v6, v6, v2
    v_add_f32 v6, v6, v3
    v_lshlrev_b32 v2, 16, v46
    v_and_b32 v3, 0xffff0000, v46
    v_fma_f32 v2, v2, s76, v15
    v_fma_f32 v3, v3, s76, v15
    v_exp_f32 v2, v2
    v_exp_f32 v3, v3
    s_nop 0
    v_add_f32 v6, v6, v2
    v_add_f32 v6, v6, v3
    v_lshlrev_b32 v2, 16, v47
    v_and_b32 v3, 0xffff0000, v47
    v_fma_f32 v2, v2, s76, v15
    v_fma_f32 v3, v3, s76, v15
    v_exp_f32 v2, v2
    v_exp_f32 v3, v3
    s_nop 0
    v_add_f32 v6, v6, v2
    v_add_f32 v6, v6, v3
    v_lshlrev_b32 v2, 16, v48
    v_and_b32 v3, 0xffff0000, v48
    v_fma_f32 v2, v2, s76, v15
    v_fma_f32 v3, v3, s76, v15
    v_exp_f32 v2, v2
    v_exp_f32 v3, v3
    s_nop 0
    v_add_f32 v6, v6, v2
    v_add_f32 v6, v6, v3
    v_lshlrev_b32 v2, 16, v49
    v_and_b32 v3, 0xffff0000, v49
    v_fma_f32 v2, v2, s76, v15
    v_fma_f32 v3, v3, s76, v15
    v_exp_f32 v2, v2
    v_exp_f32 v3, v3
    s_nop 0
    v_add_f32 v6, v6, v2
    v_add_f32 v6, v6, v3
    v_lshlrev_b32 v2, 16, v50
    v_and_b32 v3, 0xffff0000, v50
    v_fma_f32 v2, v2, s76, v15
    v_fma_f32 v3, v3, s76, v15
    v_exp_f32 v2, v2
    v_exp_f32 v3, v3
    s_nop 0
    v_add_f32 v6, v6, v2
    v_add_f32 v6, v6, v3
    v_lshlrev_b32 v2, 16, v51
    v_and_b32 v3, 0xffff0000, v51
    v_fma_f32 v2, v2, s76, v15
    v_fma_f32 v3, v3, s76, v15
    v_exp_f32 v2, v2
    v_exp_f32 v3, v3
    s_nop 0
    v_add_f32 v6, v6, v2
    v_add_f32 v6, v6, v3
    v_lshlrev_b32 v2, 16, v52
    v_and_b32 v3, 0xffff0000, v52
    v_fma_f32 v2, v2, s76, v15
    v_fma_f32 v3, v3, s76, v15
    v_exp_f32 v2, v2
    v_exp_f32 v3, v3
    s_nop 0
    v_add_f32 v6, v6, v2
    v_add_f32 v6, v6, v3
    v_lshlrev_b32 v2, 16, v53
    v_and_b32 v3, 0xffff0000, v53
    v_fma_f32 v2, v2, s76, v15
    v_fma_f32 v3, v3, s76, v15
    v_exp_f32 v2, v2
    v_exp_f32 v3, v3
    s_nop 0
    v_add_f32 v6, v6, v2
    v_add_f32 v6, v6, v3
    v_lshlrev_b32 v2, 16, v54
    v_and_b32 v3, 0xffff0000, v54
    v_fma_f32 v2, v2, s76, v15
    v_fma_f32 v3, v3, s76, v15
    v_exp_f32 v2, v2
    v_exp_f32 v3, v3
    s_nop 0
    v_add_f32 v6, v6, v2
    v_add_f32 v6, v6, v3
    v_lshlrev_b32 v2, 16, v55
    v_and_b32 v3, 0xffff0000, v55
    v_fma_f32 v2, v2, s76, v15
    v_fma_f32 v3, v3, s76, v15
    v_exp_f32 v2, v2
    v_exp_f32 v3, v3
    s_nop 0
    v_add_f32 v6, v6, v2
    v_add_f32 v6, v6, v3
    v_lshlrev_b32 v2, 16, v56
    v_and_b32 v3, 0xffff0000, v56
    v_fma_f32 v2, v2, s76, v15
    v_fma_f32 v3, v3, s76, v15
    v_exp_f32 v2, v2
    v_exp_f32 v3, v3
    s_nop 0
    v_add_f32 v6, v6, v2
    v_add_f32 v6, v6, v3
    v_lshlrev_b32 v2, 16, v57
    v_and_b32 v3, 0xffff0000, v57
    v_fma_f32 v2, v2, s76, v15
    v_fma_f32 v3, v3, s76, v15
    v_exp_f32 v2, v2
    v_exp_f32 v3, v3
    s_nop 0
    v_add_f32 v6, v6, v2
    v_add_f32 v6, v6, v3
    v_lshlrev_b32 v2, 16, v58
    v_and_b32 v3, 0xffff0000, v58
    v_fma_f32 v2, v2, s76, v15
    v_fma_f32 v3, v3, s76, v15
    v_exp_f32 v2, v2
    v_exp_f32 v3, v3
    s_nop 0
    v_add_f32 v6, v6, v2
    v_add_f32 v6, v6, v3
    v_lshlrev_b32 v2, 16, v59
    v_and_b32 v3, 0xffff0000, v59
    v_fma_f32 v2, v2, s76, v15
    v_fma_f32 v3, v3, s76, v15
    v_exp_f32 v2, v2
    v_exp_f32 v3, v3
    s_nop 0
    v_add_f32 v6, v6, v2
    v_add_f32 v6, v6, v3
    s_nop 1
    v_readlane_b32 s40, v6, 0
    v_readlane_b32 s41, v6, 16
    v_readlane_b32 s42, v6, 32
    v_readlane_b32 s43, v6, 48
    s_nop 1
    v_mov_b32 v6, s40
    v_add_f32 v6, s41, v6
    v_add_f32 v6, s42, v6
    v_add_f32 v6, s43, v6
    s_lshl_b32 s15, s12, 3
    v_mov_b32 v2, s15
    v_mov_b32 v7, v6
    v_mov_b32 v6, v8
    ds_write_b64 v2, v[6:7] offset:2560
    s_waitcnt lgkmcnt(0)
    s_barrier
    v_mov_b32 v2, 0
    ds_read_b128 v[60:63], v2 offset:2560
    ds_read_b128 v[64:67], v2 offset:2576
    ds_read_b128 v[68:71], v2 offset:2592
    ds_read_b128 v[72:75], v2 offset:2608
    s_waitcnt lgkmcnt(0)
    v_max3_f32 v8, v60, v62, v64
    v_max3_f32 v8, v66, v68, v8
    v_max3_f32 v8, v70, v72, v8
    v_max_f32 v8, v74, v8
    ds_read_b128 v[60:63], v2 offset:2624
    ds_read_b128 v[64:67], v2 offset:2640
    ds_read_b128 v[68:71], v2 offset:2656
    ds_read_b128 v[72:75], v2 offset:2672
    s_waitcnt lgkmcnt(0)
    v_max3_f32 v8, v60, v62, v8
    v_max3_f32 v8, v64, v66, v8
    v_max3_f32 v8, v68, v70, v8
    v_max3_f32 v8, v72, v74, v8
    v_mul_f32 v15, s76, v8
    v_sub_f32 v15, 0, v15
    v_mov_b32 v14, 0
    ds_read_b128 v[60:63], v2 offset:2560
    ds_read_b128 v[64:67], v2 offset:2576
    ds_read_b128 v[68:71], v2 offset:2592
    ds_read_b128 v[72:75], v2 offset:2608
    s_waitcnt lgkmcnt(0)
    v_fma_f32 v3, v60, s76, v15
    v_exp_f32 v3, v3
    s_nop 0
    v_fmac_f32 v14, v3, v61
    v_fma_f32 v3, v62, s76, v15
    v_exp_f32 v3, v3
    s_nop 0
    v_fmac_f32 v14, v3, v63
    v_fma_f32 v3, v64, s76, v15
    v_exp_f32 v3, v3
    s_nop 0
    v_fmac_f32 v14, v3, v65
    v_fma_f32 v3, v66, s76, v15
    v_exp_f32 v3, v3
    s_nop 0
    v_fmac_f32 v14, v3, v67
    v_fma_f32 v3, v68, s76, v15
    v_exp_f32 v3, v3
    s_nop 0
    v_fmac_f32 v14, v3, v69
    v_fma_f32 v3, v70, s76, v15
    v_exp_f32 v3, v3
    s_nop 0
    v_fmac_f32 v14, v3, v71
    v_fma_f32 v3, v72, s76, v15
    v_exp_f32 v3, v3
    s_nop 0
    v_fmac_f32 v14, v3, v73
    v_fma_f32 v3, v74, s76, v15
    v_exp_f32 v3, v3
    s_nop 0
    v_fmac_f32 v14, v3, v75
    ds_read_b128 v[60:63], v2 offset:2624
    ds_read_b128 v[64:67], v2 offset:2640
    ds_read_b128 v[68:71], v2 offset:2656
    ds_read_b128 v[72:75], v2 offset:2672
    s_waitcnt lgkmcnt(0)
    v_fma_f32 v3, v60, s76, v15
    v_exp_f32 v3, v3
    s_nop 0
    v_fmac_f32 v14, v3, v61
    v_fma_f32 v3, v62, s76, v15
    v_exp_f32 v3, v3
    s_nop 0
    v_fmac_f32 v14, v3, v63
    v_fma_f32 v3, v64, s76, v15
    v_exp_f32 v3, v3
    s_nop 0
    v_fmac_f32 v14, v3, v65
    v_fma_f32 v3, v66, s76, v15
    v_exp_f32 v3, v3
    s_nop 0
    v_fmac_f32 v14, v3, v67
    v_fma_f32 v3, v68, s76, v15
    v_exp_f32 v3, v3
    s_nop 0
    v_fmac_f32 v14, v3, v69
    v_fma_f32 v3, v70, s76, v15
    v_exp_f32 v3, v3
    s_nop 0
    v_fmac_f32 v14, v3, v71
    v_fma_f32 v3, v72, s76, v15
    v_exp_f32 v3, v3
    s_nop 0
    v_fmac_f32 v14, v3, v73
    v_fma_f32 v3, v74, s76, v15
    v_exp_f32 v3, v3
    s_nop 0
    v_fmac_f32 v14, v3, v75
    v_rcp_f32 v3, v14
    s_nop 0
    v_fma_f32 v4, -v14, v3, 1.0
    v_fma_f32 v14, v4, v3, v3
    v_mov_b32 v24, 0
    v_mov_b32 v25, 0
    v_mov_b32 v26, 0
    v_mov_b32 v27, 0
    s_cmp_lg_u32 s12, 2
    s_cbranch_scc1 L_gu_done
    v_lshlrev_b32 v2, 2, v1
    ds_read_b32 v60, v2 offset:11264
    ds_read_b32 v61, v2 offset:11776
    ds_read_b32 v62, v2 offset:12288
    ds_read_b32 v63, v2 offset:12800
    ds_read_b32 v64, v2 offset:13312
    ds_read_b32 v65, v2 offset:13824
    ds_read_b32 v66, v2 offset:14336
    ds_read_b32 v67, v2 offset:14848
    ds_read_b32 v68, v2 offset:15360
    ds_read_b32 v69, v2 offset:15872
    ds_read_b32 v70, v2 offset:16384
    ds_read_b32 v71, v2 offset:16896
    ds_read_b32 v72, v2 offset:17408
    ds_read_b32 v73, v2 offset:17920
    ds_read_b32 v74, v2 offset:18432
    ds_read_b32 v75, v2 offset:18944
    s_waitcnt lgkmcnt(0)
    v_mov_b32 v3, v60
    v_add_f32 v3, v3, v61
    v_add_f32 v3, v3, v62
    v_add_f32 v3, v3, v63
    v_add_f32 v3, v3, v64
    v_add_f32 v3, v3, v65
    v_add_f32 v3, v3, v66
    v_add_f32 v3, v3, v67
    v_add_f32 v3, v3, v68
    v_add_f32 v3, v3, v69
    v_add_f32 v3, v3, v70
    v_add_f32 v3, v3, v71
    v_add_f32 v3, v3, v72
    v_add_f32 v3, v3, v73
    v_add_f32 v3, v3, v74
    v_add_f32 v3, v3, v75
    ds_read_b32 v60, v2 offset:11520
    ds_read_b32 v61, v2 offset:12032
    ds_read_b32 v62, v2 offset:12544
    ds_read_b32 v63, v2 offset:13056
    ds_read_b32 v64, v2 offset:13568
    ds_read_b32 v65, v2 offset:14080
    ds_read_b32 v66, v2 offset:14592
    ds_read_b32 v67, v2 offset:15104
    ds_read_b32 v68, v2 offset:15616
    ds_read_b32 v69, v2 offset:16128
    ds_read_b32 v70, v2 offset:16640
    ds_read_b32 v71, v2 offset:17152
    ds_read_b32 v72, v2 offset:17664
    ds_read_b32 v73, v2 offset:18176
    ds_read_b32 v74, v2 offset:18688
    ds_read_b32 v75, v2 offset:19200
    s_waitcnt lgkmcnt(0)
    v_mov_b32 v4, v60
    v_add_f32 v4, v4, v61
    v_add_f32 v4, v4, v62
    v_add_f32 v4, v4, v63
    v_add_f32 v4, v4, v64
    v_add_f32 v4, v4, v65
    v_add_f32 v4, v4, v66
    v_add_f32 v4, v4, v67
    v_add_f32 v4, v4, v68
    v_add_f32 v4, v4, v69
    v_add_f32 v4, v4, v70
    v_add_f32 v4, v4, v71
    v_add_f32 v4, v4, v72
    v_add_f32 v4, v4, v73
    v_add_f32 v4, v4, v74
    v_add_f32 v4, v4, v75
    v_cvt_pk_bf16_f32 v5, v3, v4
    v_lshlrev_b32 v3, 16, v5
    v_and_b32 v4, 0xffff0000, v5
    v_max_f32 v3, 0, v3
    v_mul_f32 v3, v3, v4
    v_cvt_pk_bf16_f32 v3, v3, v3
    v_and_b32 v3, 0xffff0000, v3
    ds_write_b32 v2, v3 offset:2304
L_gu_done:
    s_lshl_b32 s15, s14, 17
    s_add_u32 s80, s24, s15
    s_addc_u32 s81, s25, 0
    s_lshl_b32 s15, s12, 13
    v_lshlrev_b32 v126, 4, v1
    v_add_u32 v126, s15, v126
    v_add_u32 v127, 0x1000, v126
    s_mul_i32 s74, s14, 43
    s_add_u32 s15, s74, s12
    s_add_u32 s73, s12, 32
    s_min_u32 s73, s73, 42
    s_add_u32 s73, s73, s74
    s_lshl_b32 s15, s15, 10
    s_lshl_b32 s73, s73, 10
    v_lshlrev_b32 v4, 4, v1
    v_add_u32 v6, s15, v4
    v_add_u32 v7, 0x4000, v6
    v_add_u32 v5, s73, v4
    v_lshlrev_b32 v2, 16, v28
    v_fma_f32 v2, v2, s76, v15
    v_exp_f32 v2, v2
    v_and_b32 v3, 0xffff0000, v28
    v_fma_f32 v3, v3, s76, v15
    v_exp_f32 v3, v3
    v_mul_f32 v2, v2, v14
    v_mul_f32 v3, v3, v14
    v_cvt_pk_bf16_f32 v2, v2, v2
    v_cvt_pk_bf16_f32 v3, v3, v3
    v_and_b32 v10, v20, v2
    v_and_b32 v11, v21, v2
    v_and_b32 v12, v22, v2
    v_and_b32 v13, v23, v2
    s_waitcnt vmcnt(11)
    s_nop 0
    v_mfma_f32_16x16x32_bf16 v[24:27], v[10:13], v[92:95], v[24:27]
    s_mov_b32 s72, 12288
    buffer_load_dwordx4 v[92:95], v9, s[8:11], s72 offen offset:0 nt
    v_and_b32 v10, v20, v3
    v_and_b32 v11, v21, v3
    v_and_b32 v12, v22, v3
    v_and_b32 v13, v23, v3
    s_waitcnt vmcnt(11)
    s_nop 0
    v_mfma_f32_16x16x32_bf16 v[24:27], v[10:13], v[96:99], v[24:27]
    s_mov_b32 s72, 12288
    buffer_load_dwordx4 v[96:99], v9, s[8:11], s72 offen offset:1024 nt
    v_lshlrev_b32 v2, 16, v29
    v_fma_f32 v2, v2, s76, v15
    v_exp_f32 v2, v2
    v_and_b32 v3, 0xffff0000, v29
    v_fma_f32 v3, v3, s76, v15
    v_exp_f32 v3, v3
    v_mul_f32 v2, v2, v14
    v_mul_f32 v3, v3, v14
    v_cvt_pk_bf16_f32 v2, v2, v2
    v_cvt_pk_bf16_f32 v3, v3, v3
    v_and_b32 v10, v20, v2
    v_and_b32 v11, v21, v2
    v_and_b32 v12, v22, v2
    v_and_b32 v13, v23, v2
    s_waitcnt vmcnt(11)
    s_nop 0
    v_mfma_f32_16x16x32_bf16 v[24:27], v[10:13], v[100:103], v[24:27]
    s_mov_b32 s72, 12288
    buffer_load_dwordx4 v[100:103], v9, s[8:11], s72 offen offset:2048 nt
    v_and_b32 v10, v20, v3
    v_and_b32 v11, v21, v3
    v_and_b32 v12, v22, v3
    v_and_b32 v13, v23, v3
    s_waitcnt vmcnt(11)
    s_nop 0
    v_mfma_f32_16x16x32_bf16 v[24:27], v[10:13], v[104:107], v[24:27]
    s_mov_b32 s72, 12288
    buffer_load_dwordx4 v[104:107], v9, s[8:11], s72 offen offset:3072 nt
    v_lshlrev_b32 v2, 16, v30
    v_fma_f32 v2, v2, s76, v15
    v_exp_f32 v2, v2
    v_and_b32 v3, 0xffff0000, v30
    v_fma_f32 v3, v3, s76, v15
    v_exp_f32 v3, v3
    v_mul_f32 v2, v2, v14
    v_mul_f32 v3, v3, v14
    v_cvt_pk_bf16_f32 v2, v2, v2
    v_cvt_pk_bf16_f32 v3, v3, v3
    v_and_b32 v10, v20, v2
    v_and_b32 v11, v21, v2
    v_and_b32 v12, v22, v2
    v_and_b32 v13, v23, v2
    s_waitcnt vmcnt(11)
    s_nop 0
    v_mfma_f32_16x16x32_bf16 v[24:27], v[10:13], v[108:111], v[24:27]
    s_mov_b32 s72, 16384
    buffer_load_dwordx4 v[108:111], v9, s[8:11], s72 offen offset:0 nt
    v_and_b32 v10, v20, v3
    v_and_b32 v11, v21, v3
    v_and_b32 v12, v22, v3
    v_and_b32 v13, v23, v3
    s_waitcnt vmcnt(11)
    s_nop 0
    v_mfma_f32_16x16x32_bf16 v[24:27], v[10:13], v[112:115], v[24:27]
    s_mov_b32 s72, 16384
    buffer_load_dwordx4 v[112:115], v9, s[8:11], s72 offen offset:1024 nt
    v_lshlrev_b32 v2, 16, v31
    v_fma_f32 v2, v2, s76, v15
    v_exp_f32 v2, v2
    v_and_b32 v3, 0xffff0000, v31
    v_fma_f32 v3, v3, s76, v15
    v_exp_f32 v3, v3
    v_mul_f32 v2, v2, v14
    v_mul_f32 v3, v3, v14
    v_cvt_pk_bf16_f32 v2, v2, v2
    v_cvt_pk_bf16_f32 v3, v3, v3
    v_and_b32 v10, v20, v2
    v_and_b32 v11, v21, v2
    v_and_b32 v12, v22, v2
    v_and_b32 v13, v23, v2
    s_waitcnt vmcnt(11)
    s_nop 0
    v_mfma_f32_16x16x32_bf16 v[24:27], v[10:13], v[116:119], v[24:27]
    s_mov_b32 s72, 16384
    buffer_load_dwordx4 v[116:119], v9, s[8:11], s72 offen offset:2048 nt
    v_and_b32 v10, v20, v3
    v_and_b32 v11, v21, v3
    v_and_b32 v12, v22, v3
    v_and_b32 v13, v23, v3
    s_waitcnt vmcnt(11)
    s_nop 0
    v_mfma_f32_16x16x32_bf16 v[24:27], v[10:13], v[120:123], v[24:27]
    s_mov_b32 s72, 16384
    buffer_load_dwordx4 v[120:123], v9, s[8:11], s72 offen offset:3072 nt
    v_lshlrev_b32 v2, 16, v32
    v_fma_f32 v2, v2, s76, v15
    v_exp_f32 v2, v2
    v_and_b32 v3, 0xffff0000, v32
    v_fma_f32 v3, v3, s76, v15
    v_exp_f32 v3, v3
    v_mul_f32 v2, v2, v14
    v_mul_f32 v3, v3, v14
    v_cvt_pk_bf16_f32 v2, v2, v2
    v_cvt_pk_bf16_f32 v3, v3, v3
    v_and_b32 v10, v20, v2
    v_and_b32 v11, v21, v2
    v_and_b32 v12, v22, v2
    v_and_b32 v13, v23, v2
    s_waitcnt vmcnt(11)
    s_nop 0
    v_mfma_f32_16x16x32_bf16 v[24:27], v[10:13], v[76:79], v[24:27]
    s_mov_b32 s72, 20480
    buffer_load_dwordx4 v[76:79], v9, s[8:11], s72 offen offset:0 nt
    v_and_b32 v10, v20, v3
    v_and_b32 v11, v21, v3
    v_and_b32 v12, v22, v3
    v_and_b32 v13, v23, v3
    s_waitcnt vmcnt(11)
    s_nop 0
    v_mfma_f32_16x16x32_bf16 v[24:27], v[10:13], v[80:83], v[24:27]
    s_mov_b32 s72, 20480
    buffer_load_dwordx4 v[80:83], v9, s[8:11], s72 offen offset:1024 nt
    v_lshlrev_b32 v2, 16, v33
    v_fma_f32 v2, v2, s76, v15
    v_exp_f32 v2, v2
    v_and_b32 v3, 0xffff0000, v33
    v_fma_f32 v3, v3, s76, v15
    v_exp_f32 v3, v3
    v_mul_f32 v2, v2, v14
    v_mul_f32 v3, v3, v14
    v_cvt_pk_bf16_f32 v2, v2, v2
    v_cvt_pk_bf16_f32 v3, v3, v3
    v_and_b32 v10, v20, v2
    v_and_b32 v11, v21, v2
    v_and_b32 v12, v22, v2
    v_and_b32 v13, v23, v2
    s_waitcnt vmcnt(11)
    s_nop 0
    v_mfma_f32_16x16x32_bf16 v[24:27], v[10:13], v[84:87], v[24:27]
    s_mov_b32 s72, 20480
    buffer_load_dwordx4 v[84:87], v9, s[8:11], s72 offen offset:2048 nt
    v_and_b32 v10, v20, v3
    v_and_b32 v11, v21, v3
    v_and_b32 v12, v22, v3
    v_and_b32 v13, v23, v3
    s_waitcnt vmcnt(11)
    s_nop 0
    v_mfma_f32_16x16x32_bf16 v[24:27], v[10:13], v[88:91], v[24:27]
    s_mov_b32 s72, 20480
    buffer_load_dwordx4 v[88:91], v9, s[8:11], s72 offen offset:3072 nt
    v_lshlrev_b32 v2, 16, v34
    v_fma_f32 v2, v2, s76, v15
    v_exp_f32 v2, v2
    v_and_b32 v3, 0xffff0000, v34
    v_fma_f32 v3, v3, s76, v15
    v_exp_f32 v3, v3
    v_mul_f32 v2, v2, v14
    v_mul_f32 v3, v3, v14
    v_cvt_pk_bf16_f32 v2, v2, v2
    v_cvt_pk_bf16_f32 v3, v3, v3
    v_and_b32 v10, v20, v2
    v_and_b32 v11, v21, v2
    v_and_b32 v12, v22, v2
    v_and_b32 v13, v23, v2
    s_waitcnt vmcnt(11)
    s_nop 0
    v_mfma_f32_16x16x32_bf16 v[24:27], v[10:13], v[92:95], v[24:27]
    s_mov_b32 s72, 24576
    buffer_load_dwordx4 v[92:95], v9, s[8:11], s72 offen offset:0 nt
    v_and_b32 v10, v20, v3
    v_and_b32 v11, v21, v3
    v_and_b32 v12, v22, v3
    v_and_b32 v13, v23, v3
    s_waitcnt vmcnt(11)
    s_nop 0
    v_mfma_f32_16x16x32_bf16 v[24:27], v[10:13], v[96:99], v[24:27]
    s_mov_b32 s72, 24576
    buffer_load_dwordx4 v[96:99], v9, s[8:11], s72 offen offset:1024 nt
    v_lshlrev_b32 v2, 16, v35
    v_fma_f32 v2, v2, s76, v15
    v_exp_f32 v2, v2
    v_and_b32 v3, 0xffff0000, v35
    v_fma_f32 v3, v3, s76, v15
    v_exp_f32 v3, v3
    v_mul_f32 v2, v2, v14
    v_mul_f32 v3, v3, v14
    v_cvt_pk_bf16_f32 v2, v2, v2
    v_cvt_pk_bf16_f32 v3, v3, v3
    v_and_b32 v10, v20, v2
    v_and_b32 v11, v21, v2
    v_and_b32 v12, v22, v2
    v_and_b32 v13, v23, v2
    s_waitcnt vmcnt(11)
    s_nop 0
    v_mfma_f32_16x16x32_bf16 v[24:27], v[10:13], v[100:103], v[24:27]
    s_mov_b32 s72, 24576
    buffer_load_dwordx4 v[100:103], v9, s[8:11], s72 offen offset:2048 nt
    v_and_b32 v10, v20, v3
    v_and_b32 v11, v21, v3
    v_and_b32 v12, v22, v3
    v_and_b32 v13, v23, v3
    s_waitcnt vmcnt(11)
    s_nop 0
    v_mfma_f32_16x16x32_bf16 v[24:27], v[10:13], v[104:107], v[24:27]
    s_mov_b32 s72, 24576
    buffer_load_dwordx4 v[104:107], v9, s[8:11], s72 offen offset:3072 nt
    v_lshlrev_b32 v2, 16, v36
    v_fma_f32 v2, v2, s76, v15
    v_exp_f32 v2, v2
    v_and_b32 v3, 0xffff0000, v36
    v_fma_f32 v3, v3, s76, v15
    v_exp_f32 v3, v3
    v_mul_f32 v2, v2, v14
    v_mul_f32 v3, v3, v14
    v_cvt_pk_bf16_f32 v2, v2, v2
    v_cvt_pk_bf16_f32 v3, v3, v3
    v_and_b32 v10, v20, v2
    v_and_b32 v11, v21, v2
    v_and_b32 v12, v22, v2
    v_and_b32 v13, v23, v2
    s_waitcnt vmcnt(11)
    s_nop 0
    v_mfma_f32_16x16x32_bf16 v[24:27], v[10:13], v[108:111], v[24:27]
    s_mov_b32 s72, 28672
    buffer_load_dwordx4 v[108:111], v9, s[8:11], s72 offen offset:0 nt
    v_and_b32 v10, v20, v3
    v_and_b32 v11, v21, v3
    v_and_b32 v12, v22, v3
    v_and_b32 v13, v23, v3
    s_waitcnt vmcnt(11)
    s_nop 0
    v_mfma_f32_16x16x32_bf16 v[24:27], v[10:13], v[112:115], v[24:27]
    s_mov_b32 s72, 28672
    buffer_load_dwordx4 v[112:115], v9, s[8:11], s72 offen offset:1024 nt
    v_lshlrev_b32 v2, 16, v37
    v_fma_f32 v2, v2, s76, v15
    v_exp_f32 v2, v2
    v_and_b32 v3, 0xffff0000, v37
    v_fma_f32 v3, v3, s76, v15
    v_exp_f32 v3, v3
    v_mul_f32 v2, v2, v14
    v_mul_f32 v3, v3, v14
    v_cvt_pk_bf16_f32 v2, v2, v2
    v_cvt_pk_bf16_f32 v3, v3, v3
    v_and_b32 v10, v20, v2
    v_and_b32 v11, v21, v2
    v_and_b32 v12, v22, v2
    v_and_b32 v13, v23, v2
    s_waitcnt vmcnt(11)
    s_nop 0
    v_mfma_f32_16x16x32_bf16 v[24:27], v[10:13], v[116:119], v[24:27]
    s_mov_b32 s72, 28672
    buffer_load_dwordx4 v[116:119], v9, s[8:11], s72 offen offset:2048 nt
    v_and_b32 v10, v20, v3
    v_and_b32 v11, v21, v3
    v_and_b32 v12, v22, v3
    v_and_b32 v13, v23, v3
    s_waitcnt vmcnt(11)
    s_nop 0
    v_mfma_f32_16x16x32_bf16 v[24:27], v[10:13], v[120:123], v[24:27]
    s_mov_b32 s72, 28672
    buffer_load_dwordx4 v[120:123], v9, s[8:11], s72 offen offset:3072 nt
    v_lshlrev_b32 v2, 16, v38
    v_fma_f32 v2, v2, s76, v15
    v_exp_f32 v2, v2
    v_and_b32 v3, 0xffff0000, v38
    v_fma_f32 v3, v3, s76, v15
    v_exp_f32 v3, v3
    v_mul_f32 v2, v2, v14
    v_mul_f32 v3, v3, v14
    v_cvt_pk_bf16_f32 v2, v2, v2
    v_cvt_pk_bf16_f32 v3, v3, v3
    v_and_b32 v10, v20, v2
    v_and_b32 v11, v21, v2
    v_and_b32 v12, v22, v2
    v_and_b32 v13, v23, v2
    s_waitcnt vmcnt(11)
    s_nop 0
    v_mfma_f32_16x16x32_bf16 v[24:27], v[10:13], v[76:79], v[24:27]
    s_mov_b32 s72, 32768
    buffer_load_dwordx4 v[76:79], v9, s[8:11], s72 offen offset:0 nt
    v_and_b32 v10, v20, v3
    v_and_b32 v11, v21, v3
    v_and_b32 v12, v22, v3
    v_and_b32 v13, v23, v3
    s_waitcnt vmcnt(11)
    s_nop 0
    v_mfma_f32_16x16x32_bf16 v[24:27], v[10:13], v[80:83], v[24:27]
    s_mov_b32 s72, 32768
    buffer_load_dwordx4 v[80:83], v9, s[8:11], s72 offen offset:1024 nt
    v_lshlrev_b32 v2, 16, v39
    v_fma_f32 v2, v2, s76, v15
    v_exp_f32 v2, v2
    v_and_b32 v3, 0xffff0000, v39
    v_fma_f32 v3, v3, s76, v15
    v_exp_f32 v3, v3
    v_mul_f32 v2, v2, v14
    v_mul_f32 v3, v3, v14
    v_cvt_pk_bf16_f32 v2, v2, v2
    v_cvt_pk_bf16_f32 v3, v3, v3
    v_and_b32 v10, v20, v2
    v_and_b32 v11, v21, v2
    v_and_b32 v12, v22, v2
    v_and_b32 v13, v23, v2
    s_waitcnt vmcnt(11)
    s_nop 0
    v_mfma_f32_16x16x32_bf16 v[24:27], v[10:13], v[84:87], v[24:27]
    s_mov_b32 s72, 32768
    buffer_load_dwordx4 v[84:87], v9, s[8:11], s72 offen offset:2048 nt
    v_and_b32 v10, v20, v3
    v_and_b32 v11, v21, v3
    v_and_b32 v12, v22, v3
    v_and_b32 v13, v23, v3
    s_waitcnt vmcnt(11)
    s_nop 0
    v_mfma_f32_16x16x32_bf16 v[24:27], v[10:13], v[88:91], v[24:27]
    s_mov_b32 s72, 32768
    buffer_load_dwordx4 v[88:91], v9, s[8:11], s72 offen offset:3072 nt
    v_lshlrev_b32 v2, 16, v40
    v_fma_f32 v2, v2, s76, v15
    v_exp_f32 v2, v2
    v_and_b32 v3, 0xffff0000, v40
    v_fma_f32 v3, v3, s76, v15
    v_exp_f32 v3, v3
    v_mul_f32 v2, v2, v14
    v_mul_f32 v3, v3, v14
    v_cvt_pk_bf16_f32 v2, v2, v2
    v_cvt_pk_bf16_f32 v3, v3, v3
    v_and_b32 v10, v20, v2
    v_and_b32 v11, v21, v2
    v_and_b32 v12, v22, v2
    v_and_b32 v13, v23, v2
    s_waitcnt vmcnt(11)
    s_nop 0
    v_mfma_f32_16x16x32_bf16 v[24:27], v[10:13], v[92:95], v[24:27]
    s_mov_b32 s72, 36864
    buffer_load_dwordx4 v[92:95], v9, s[8:11], s72 offen offset:0 nt
    v_and_b32 v10, v20, v3
    v_and_b32 v11, v21, v3
    v_and_b32 v12, v22, v3
    v_and_b32 v13, v23, v3
    s_waitcnt vmcnt(11)
    s_nop 0
    v_mfma_f32_16x16x32_bf16 v[24:27], v[10:13], v[96:99], v[24:27]
    s_mov_b32 s72, 36864
    buffer_load_dwordx4 v[96:99], v9, s[8:11], s72 offen offset:1024 nt
    v_lshlrev_b32 v2, 16, v41
    v_fma_f32 v2, v2, s76, v15
    v_exp_f32 v2, v2
    v_and_b32 v3, 0xffff0000, v41
    v_fma_f32 v3, v3, s76, v15
    v_exp_f32 v3, v3
    v_mul_f32 v2, v2, v14
    v_mul_f32 v3, v3, v14
    v_cvt_pk_bf16_f32 v2, v2, v2
    v_cvt_pk_bf16_f32 v3, v3, v3
    v_and_b32 v10, v20, v2
    v_and_b32 v11, v21, v2
    v_and_b32 v12, v22, v2
    v_and_b32 v13, v23, v2
    s_waitcnt vmcnt(11)
    s_nop 0
    v_mfma_f32_16x16x32_bf16 v[24:27], v[10:13], v[100:103], v[24:27]
    s_mov_b32 s72, 36864
    buffer_load_dwordx4 v[100:103], v9, s[8:11], s72 offen offset:2048 nt
    v_and_b32 v10, v20, v3
    v_and_b32 v11, v21, v3
    v_and_b32 v12, v22, v3
    v_and_b32 v13, v23, v3
    s_waitcnt vmcnt(11)
    s_nop 0
    v_mfma_f32_16x16x32_bf16 v[24:27], v[10:13], v[104:107], v[24:27]
    s_mov_b32 s72, 36864
    buffer_load_dwordx4 v[104:107], v9, s[8:11], s72 offen offset:3072 nt
    v_lshlrev_b32 v2, 16, v42
    v_fma_f32 v2, v2, s76, v15
    v_exp_f32 v2, v2
    v_and_b32 v3, 0xffff0000, v42
    v_fma_f32 v3, v3, s76, v15
    v_exp_f32 v3, v3
    v_mul_f32 v2, v2, v14
    v_mul_f32 v3, v3, v14
    v_cvt_pk_bf16_f32 v2, v2, v2
    v_cvt_pk_bf16_f32 v3, v3, v3
    v_and_b32 v10, v20, v2
    v_and_b32 v11, v21, v2
    v_and_b32 v12, v22, v2
    v_and_b32 v13, v23, v2
    s_waitcnt vmcnt(11)
    s_nop 0
    v_mfma_f32_16x16x32_bf16 v[24:27], v[10:13], v[108:111], v[24:27]
    s_mov_b32 s72, 40960
    buffer_load_dwordx4 v[108:111], v9, s[8:11], s72 offen offset:0 nt
    v_and_b32 v10, v20, v3
    v_and_b32 v11, v21, v3
    v_and_b32 v12, v22, v3
    v_and_b32 v13, v23, v3
    s_waitcnt vmcnt(11)
    s_nop 0
    v_mfma_f32_16x16x32_bf16 v[24:27], v[10:13], v[112:115], v[24:27]
    s_mov_b32 s72, 40960
    buffer_load_dwordx4 v[112:115], v9, s[8:11], s72 offen offset:1024 nt
    v_lshlrev_b32 v2, 16, v43
    v_fma_f32 v2, v2, s76, v15
    v_exp_f32 v2, v2
    v_and_b32 v3, 0xffff0000, v43
    v_fma_f32 v3, v3, s76, v15
    v_exp_f32 v3, v3
    v_mul_f32 v2, v2, v14
    v_mul_f32 v3, v3, v14
    v_cvt_pk_bf16_f32 v2, v2, v2
    v_cvt_pk_bf16_f32 v3, v3, v3
    v_and_b32 v10, v20, v2
    v_and_b32 v11, v21, v2
    v_and_b32 v12, v22, v2
    v_and_b32 v13, v23, v2
    s_waitcnt vmcnt(11)
    s_nop 0
    v_mfma_f32_16x16x32_bf16 v[24:27], v[10:13], v[116:119], v[24:27]
    s_mov_b32 s72, 40960
    buffer_load_dwordx4 v[116:119], v9, s[8:11], s72 offen offset:2048 nt
    v_and_b32 v10, v20, v3
    v_and_b32 v11, v21, v3
    v_and_b32 v12, v22, v3
    v_and_b32 v13, v23, v3
    s_waitcnt vmcnt(11)
    s_nop 0
    v_mfma_f32_16x16x32_bf16 v[24:27], v[10:13], v[120:123], v[24:27]
    s_mov_b32 s72, 40960
    buffer_load_dwordx4 v[120:123], v9, s[8:11], s72 offen offset:3072 nt
    v_lshlrev_b32 v2, 16, v44
    v_fma_f32 v2, v2, s76, v15
    v_exp_f32 v2, v2
    v_and_b32 v3, 0xffff0000, v44
    v_fma_f32 v3, v3, s76, v15
    v_exp_f32 v3, v3
    v_mul_f32 v2, v2, v14
    v_mul_f32 v3, v3, v14
    v_cvt_pk_bf16_f32 v2, v2, v2
    v_cvt_pk_bf16_f32 v3, v3, v3
    v_and_b32 v10, v20, v2
    v_and_b32 v11, v21, v2
    v_and_b32 v12, v22, v2
    v_and_b32 v13, v23, v2
    s_waitcnt vmcnt(11)
    s_nop 0
    v_mfma_f32_16x16x32_bf16 v[24:27], v[10:13], v[76:79], v[24:27]
    s_mov_b32 s72, 45056
    buffer_load_dwordx4 v[76:79], v9, s[8:11], s72 offen offset:0 nt
    v_and_b32 v10, v20, v3
    v_and_b32 v11, v21, v3
    v_and_b32 v12, v22, v3
    v_and_b32 v13, v23, v3
    s_waitcnt vmcnt(11)
    s_nop 0
    v_mfma_f32_16x16x32_bf16 v[24:27], v[10:13], v[80:83], v[24:27]
    s_mov_b32 s72, 45056
    buffer_load_dwordx4 v[80:83], v9, s[8:11], s72 offen offset:1024 nt
    v_lshlrev_b32 v2, 16, v45
    v_fma_f32 v2, v2, s76, v15
    v_exp_f32 v2, v2
    v_and_b32 v3, 0xffff0000, v45
    v_fma_f32 v3, v3, s76, v15
    v_exp_f32 v3, v3
    v_mul_f32 v2, v2, v14
    v_mul_f32 v3, v3, v14
    v_cvt_pk_bf16_f32 v2, v2, v2
    v_cvt_pk_bf16_f32 v3, v3, v3
    v_and_b32 v10, v20, v2
    v_and_b32 v11, v21, v2
    v_and_b32 v12, v22, v2
    v_and_b32 v13, v23, v2
    s_waitcnt vmcnt(11)
    s_nop 0
    v_mfma_f32_16x16x32_bf16 v[24:27], v[10:13], v[84:87], v[24:27]
    s_mov_b32 s72, 45056
    buffer_load_dwordx4 v[84:87], v9, s[8:11], s72 offen offset:2048 nt
    v_and_b32 v10, v20, v3
    v_and_b32 v11, v21, v3
    v_and_b32 v12, v22, v3
    v_and_b32 v13, v23, v3
    s_waitcnt vmcnt(11)
    s_nop 0
    v_mfma_f32_16x16x32_bf16 v[24:27], v[10:13], v[88:91], v[24:27]
    s_mov_b32 s72, 45056
    buffer_load_dwordx4 v[88:91], v9, s[8:11], s72 offen offset:3072 nt
    v_lshlrev_b32 v2, 16, v46
    v_fma_f32 v2, v2, s76, v15
    v_exp_f32 v2, v2
    v_and_b32 v3, 0xffff0000, v46
    v_fma_f32 v3, v3, s76, v15
    v_exp_f32 v3, v3
    v_mul_f32 v2, v2, v14
    v_mul_f32 v3, v3, v14
    v_cvt_pk_bf16_f32 v2, v2, v2
    v_cvt_pk_bf16_f32 v3, v3, v3
    v_and_b32 v10, v20, v2
    v_and_b32 v11, v21, v2
    v_and_b32 v12, v22, v2
    v_and_b32 v13, v23, v2
    s_waitcnt vmcnt(11)
    s_nop 0
    v_mfma_f32_16x16x32_bf16 v[24:27], v[10:13], v[92:95], v[24:27]
    s_mov_b32 s72, 49152
    buffer_load_dwordx4 v[92:95], v9, s[8:11], s72 offen offset:0 nt
    v_and_b32 v10, v20, v3
    v_and_b32 v11, v21, v3
    v_and_b32 v12, v22, v3
    v_and_b32 v13, v23, v3
    s_waitcnt vmcnt(11)
    s_nop 0
    v_mfma_f32_16x16x32_bf16 v[24:27], v[10:13], v[96:99], v[24:27]
    s_mov_b32 s72, 49152
    buffer_load_dwordx4 v[96:99], v9, s[8:11], s72 offen offset:1024 nt
    v_lshlrev_b32 v2, 16, v47
    v_fma_f32 v2, v2, s76, v15
    v_exp_f32 v2, v2
    v_and_b32 v3, 0xffff0000, v47
    v_fma_f32 v3, v3, s76, v15
    v_exp_f32 v3, v3
    v_mul_f32 v2, v2, v14
    v_mul_f32 v3, v3, v14
    v_cvt_pk_bf16_f32 v2, v2, v2
    v_cvt_pk_bf16_f32 v3, v3, v3
    v_and_b32 v10, v20, v2
    v_and_b32 v11, v21, v2
    v_and_b32 v12, v22, v2
    v_and_b32 v13, v23, v2
    s_waitcnt vmcnt(11)
    s_nop 0
    v_mfma_f32_16x16x32_bf16 v[24:27], v[10:13], v[100:103], v[24:27]
    s_mov_b32 s72, 49152
    buffer_load_dwordx4 v[100:103], v9, s[8:11], s72 offen offset:2048 nt
    v_and_b32 v10, v20, v3
    v_and_b32 v11, v21, v3
    v_and_b32 v12, v22, v3
    v_and_b32 v13, v23, v3
    s_waitcnt vmcnt(11)
    s_nop 0
    v_mfma_f32_16x16x32_bf16 v[24:27], v[10:13], v[104:107], v[24:27]
    s_mov_b32 s72, 49152
    buffer_load_dwordx4 v[104:107], v9, s[8:11], s72 offen offset:3072 nt
    v_lshlrev_b32 v2, 16, v48
    v_fma_f32 v2, v2, s76, v15
    v_exp_f32 v2, v2
    v_and_b32 v3, 0xffff0000, v48
    v_fma_f32 v3, v3, s76, v15
    v_exp_f32 v3, v3
    v_mul_f32 v2, v2, v14
    v_mul_f32 v3, v3, v14
    v_cvt_pk_bf16_f32 v2, v2, v2
    v_cvt_pk_bf16_f32 v3, v3, v3
    v_and_b32 v10, v20, v2
    v_and_b32 v11, v21, v2
    v_and_b32 v12, v22, v2
    v_and_b32 v13, v23, v2
    s_waitcnt vmcnt(11)
    s_nop 0
    v_mfma_f32_16x16x32_bf16 v[24:27], v[10:13], v[108:111], v[24:27]
    s_mov_b32 s72, 53248
    buffer_load_dwordx4 v[108:111], v9, s[8:11], s72 offen offset:0 nt
    v_and_b32 v10, v20, v3
    v_and_b32 v11, v21, v3
    v_and_b32 v12, v22, v3
    v_and_b32 v13, v23, v3
    s_waitcnt vmcnt(11)
    s_nop 0
    v_mfma_f32_16x16x32_bf16 v[24:27], v[10:13], v[112:115], v[24:27]
    s_mov_b32 s72, 53248
    buffer_load_dwordx4 v[112:115], v9, s[8:11], s72 offen offset:1024 nt
    v_lshlrev_b32 v2, 16, v49
    v_fma_f32 v2, v2, s76, v15
    v_exp_f32 v2, v2
    v_and_b32 v3, 0xffff0000, v49
    v_fma_f32 v3, v3, s76, v15
    v_exp_f32 v3, v3
    v_mul_f32 v2, v2, v14
    v_mul_f32 v3, v3, v14
    v_cvt_pk_bf16_f32 v2, v2, v2
    v_cvt_pk_bf16_f32 v3, v3, v3
    v_and_b32 v10, v20, v2
    v_and_b32 v11, v21, v2
    v_and_b32 v12, v22, v2
    v_and_b32 v13, v23, v2
    s_waitcnt vmcnt(11)
    s_nop 0
    v_mfma_f32_16x16x32_bf16 v[24:27], v[10:13], v[116:119], v[24:27]
    s_mov_b32 s72, 53248
    buffer_load_dwordx4 v[116:119], v9, s[8:11], s72 offen offset:2048 nt
    v_and_b32 v10, v20, v3
    v_and_b32 v11, v21, v3
    v_and_b32 v12, v22, v3
    v_and_b32 v13, v23, v3
    s_waitcnt vmcnt(11)
    s_nop 0
    v_mfma_f32_16x16x32_bf16 v[24:27], v[10:13], v[120:123], v[24:27]
    s_mov_b32 s72, 53248
    buffer_load_dwordx4 v[120:123], v9, s[8:11], s72 offen offset:3072 nt
    v_lshlrev_b32 v2, 16, v50
    v_fma_f32 v2, v2, s76, v15
    v_exp_f32 v2, v2
    v_and_b32 v3, 0xffff0000, v50
    v_fma_f32 v3, v3, s76, v15
    v_exp_f32 v3, v3
    v_mul_f32 v2, v2, v14
    v_mul_f32 v3, v3, v14
    v_cvt_pk_bf16_f32 v2, v2, v2
    v_cvt_pk_bf16_f32 v3, v3, v3
    v_and_b32 v10, v20, v2
    v_and_b32 v11, v21, v2
    v_and_b32 v12, v22, v2
    v_and_b32 v13, v23, v2
    s_waitcnt vmcnt(11)
    s_nop 0
    v_mfma_f32_16x16x32_bf16 v[24:27], v[10:13], v[76:79], v[24:27]
    s_mov_b32 s72, 57344
    buffer_load_dwordx4 v[76:79], v9, s[8:11], s72 offen offset:0 nt
    v_and_b32 v10, v20, v3
    v_and_b32 v11, v21, v3
    v_and_b32 v12, v22, v3
    v_and_b32 v13, v23, v3
    s_waitcnt vmcnt(11)
    s_nop 0
    v_mfma_f32_16x16x32_bf16 v[24:27], v[10:13], v[80:83], v[24:27]
    s_mov_b32 s72, 57344
    buffer_load_dwordx4 v[80:83], v9, s[8:11], s72 offen offset:1024 nt
    v_lshlrev_b32 v2, 16, v51
    v_fma_f32 v2, v2, s76, v15
    v_exp_f32 v2, v2
    v_and_b32 v3, 0xffff0000, v51
    v_fma_f32 v3, v3, s76, v15
    v_exp_f32 v3, v3
    v_mul_f32 v2, v2, v14
    v_mul_f32 v3, v3, v14
    v_cvt_pk_bf16_f32 v2, v2, v2
    v_cvt_pk_bf16_f32 v3, v3, v3
    v_and_b32 v10, v20, v2
    v_and_b32 v11, v21, v2
    v_and_b32 v12, v22, v2
    v_and_b32 v13, v23, v2
    s_waitcnt vmcnt(11)
    s_nop 0
    v_mfma_f32_16x16x32_bf16 v[24:27], v[10:13], v[84:87], v[24:27]
    s_mov_b32 s72, 57344
    buffer_load_dwordx4 v[84:87], v9, s[8:11], s72 offen offset:2048 nt
    v_and_b32 v10, v20, v3
    v_and_b32 v11, v21, v3
    v_and_b32 v12, v22, v3
    v_and_b32 v13, v23, v3
    s_waitcnt vmcnt(11)
    s_nop 0
    v_mfma_f32_16x16x32_bf16 v[24:27], v[10:13], v[88:91], v[24:27]
    s_mov_b32 s72, 57344
    buffer_load_dwordx4 v[88:91], v9, s[8:11], s72 offen offset:3072 nt
    v_lshlrev_b32 v2, 16, v52
    v_fma_f32 v2, v2, s76, v15
    v_exp_f32 v2, v2
    v_and_b32 v3, 0xffff0000, v52
    v_fma_f32 v3, v3, s76, v15
    v_exp_f32 v3, v3
    v_mul_f32 v2, v2, v14
    v_mul_f32 v3, v3, v14
    v_cvt_pk_bf16_f32 v2, v2, v2
    v_cvt_pk_bf16_f32 v3, v3, v3
    v_and_b32 v10, v20, v2
    v_and_b32 v11, v21, v2
    v_and_b32 v12, v22, v2
    v_and_b32 v13, v23, v2
    s_waitcnt vmcnt(11)
    s_nop 0
    v_mfma_f32_16x16x32_bf16 v[24:27], v[10:13], v[92:95], v[24:27]
    s_mov_b32 s72, 61440
    buffer_load_dwordx4 v[92:95], v9, s[8:11], s72 offen offset:0 nt
    v_and_b32 v10, v20, v3
    v_and_b32 v11, v21, v3
    v_and_b32 v12, v22, v3
    v_and_b32 v13, v23, v3
    s_waitcnt vmcnt(11)
    s_nop 0
    v_mfma_f32_16x16x32_bf16 v[24:27], v[10:13], v[96:99], v[24:27]
    s_mov_b32 s72, 61440
    buffer_load_dwordx4 v[96:99], v9, s[8:11], s72 offen offset:1024 nt
    v_lshlrev_b32 v2, 16, v53
    v_fma_f32 v2, v2, s76, v15
    v_exp_f32 v2, v2
    v_and_b32 v3, 0xffff0000, v53
    v_fma_f32 v3, v3, s76, v15
    v_exp_f32 v3, v3
    v_mul_f32 v2, v2, v14
    v_mul_f32 v3, v3, v14
    v_cvt_pk_bf16_f32 v2, v2, v2
    v_cvt_pk_bf16_f32 v3, v3, v3
    v_and_b32 v10, v20, v2
    v_and_b32 v11, v21, v2
    v_and_b32 v12, v22, v2
    v_and_b32 v13, v23, v2
    s_waitcnt vmcnt(11)
    s_nop 0
    v_mfma_f32_16x16x32_bf16 v[24:27], v[10:13], v[100:103], v[24:27]
    s_mov_b32 s72, 61440
    buffer_load_dwordx4 v[100:103], v9, s[8:11], s72 offen offset:2048 nt
    v_and_b32 v10, v20, v3
    v_and_b32 v11, v21, v3
    v_and_b32 v12, v22, v3
    v_and_b32 v13, v23, v3
    s_waitcnt vmcnt(11)
    s_nop 0
    v_mfma_f32_16x16x32_bf16 v[24:27], v[10:13], v[104:107], v[24:27]
    s_mov_b32 s72, 61440
    buffer_load_dwordx4 v[104:107], v9, s[8:11], s72 offen offset:3072 nt
    v_lshlrev_b32 v2, 16, v54
    v_fma_f32 v2, v2, s76, v15
    v_exp_f32 v2, v2
    v_and_b32 v3, 0xffff0000, v54
    v_fma_f32 v3, v3, s76, v15
    v_exp_f32 v3, v3
    v_mul_f32 v2, v2, v14
    v_mul_f32 v3, v3, v14
    v_cvt_pk_bf16_f32 v2, v2, v2
    v_cvt_pk_bf16_f32 v3, v3, v3
    v_and_b32 v10, v20, v2
    v_and_b32 v11, v21, v2
    v_and_b32 v12, v22, v2
    v_and_b32 v13, v23, v2
    s_waitcnt vmcnt(11)
    s_nop 0
    v_mfma_f32_16x16x32_bf16 v[24:27], v[10:13], v[108:111], v[24:27]
    global_load_dwordx4 v[108:111], v126, s[80:81] offset:0
    v_and_b32 v10, v20, v3
    v_and_b32 v11, v21, v3
    v_and_b32 v12, v22, v3
    v_and_b32 v13, v23, v3
    s_waitcnt vmcnt(11)
    s_nop 0
    v_mfma_f32_16x16x32_bf16 v[24:27], v[10:13], v[112:115], v[24:27]
    global_load_dwordx4 v[112:115], v126, s[80:81] offset:1024
    v_lshlrev_b32 v2, 16, v55
    v_fma_f32 v2, v2, s76, v15
    v_exp_f32 v2, v2
    v_and_b32 v3, 0xffff0000, v55
    v_fma_f32 v3, v3, s76, v15
    v_exp_f32 v3, v3
    v_mul_f32 v2, v2, v14
    v_mul_f32 v3, v3, v14
    v_cvt_pk_bf16_f32 v2, v2, v2
    v_cvt_pk_bf16_f32 v3, v3, v3
    v_and_b32 v10, v20, v2
    v_and_b32 v11, v21, v2
    v_and_b32 v12, v22, v2
    v_and_b32 v13, v23, v2
    s_waitcnt vmcnt(11)
    s_nop 0
    v_mfma_f32_16x16x32_bf16 v[24:27], v[10:13], v[116:119], v[24:27]
    global_load_dwordx4 v[116:119], v126, s[80:81] offset:2048
    v_and_b32 v10, v20, v3
    v_and_b32 v11, v21, v3
    v_and_b32 v12, v22, v3
    v_and_b32 v13, v23, v3
    s_waitcnt vmcnt(11)
    s_nop 0
    v_mfma_f32_16x16x32_bf16 v[24:27], v[10:13], v[120:123], v[24:27]
    global_load_dwordx4 v[120:123], v126, s[80:81] offset:3072
    v_lshlrev_b32 v2, 16, v56
    v_fma_f32 v2, v2, s76, v15
    v_exp_f32 v2, v2
    v_and_b32 v3, 0xffff0000, v56
    v_fma_f32 v3, v3, s76, v15
    v_exp_f32 v3, v3
    v_mul_f32 v2, v2, v14
    v_mul_f32 v3, v3, v14
    v_cvt_pk_bf16_f32 v2, v2, v2
    v_cvt_pk_bf16_f32 v3, v3, v3
    v_and_b32 v10, v20, v2
    v_and_b32 v11, v21, v2
    v_and_b32 v12, v22, v2
    v_and_b32 v13, v23, v2
    s_waitcnt vmcnt(11)
    s_nop 0
    v_mfma_f32_16x16x32_bf16 v[24:27], v[10:13], v[76:79], v[24:27]
    global_load_dwordx4 v[76:79], v127, s[80:81] offset:0
    v_and_b32 v10, v20, v3
    v_and_b32 v11, v21, v3
    v_and_b32 v12, v22, v3
    v_and_b32 v13, v23, v3
    s_waitcnt vmcnt(11)
    s_nop 0
    v_mfma_f32_16x16x32_bf16 v[24:27], v[10:13], v[80:83], v[24:27]
    global_load_dwordx4 v[80:83], v127, s[80:81] offset:1024
    v_lshlrev_b32 v2, 16, v57
    v_fma_f32 v2, v2, s76, v15
    v_exp_f32 v2, v2
    v_and_b32 v3, 0xffff0000, v57
    v_fma_f32 v3, v3, s76, v15
    v_exp_f32 v3, v3
    v_mul_f32 v2, v2, v14
    v_mul_f32 v3, v3, v14
    v_cvt_pk_bf16_f32 v2, v2, v2
    v_cvt_pk_bf16_f32 v3, v3, v3
    v_and_b32 v10, v20, v2
    v_and_b32 v11, v21, v2
    v_and_b32 v12, v22, v2
    v_and_b32 v13, v23, v2
    s_waitcnt vmcnt(11)
    s_nop 0
    v_mfma_f32_16x16x32_bf16 v[24:27], v[10:13], v[84:87], v[24:27]
    global_load_dwordx4 v[84:87], v127, s[80:81] offset:2048
    v_and_b32 v10, v20, v3
    v_and_b32 v11, v21, v3
    v_and_b32 v12, v22, v3
    v_and_b32 v13, v23, v3
    s_waitcnt vmcnt(11)
    s_nop 0
    v_mfma_f32_16x16x32_bf16 v[24:27], v[10:13], v[88:91], v[24:27]
    global_load_dwordx4 v[88:91], v127, s[80:81] offset:3072
    v_lshlrev_b32 v2, 16, v58
    v_fma_f32 v2, v2, s76, v15
    v_exp_f32 v2, v2
    v_and_b32 v3, 0xffff0000, v58
    v_fma_f32 v3, v3, s76, v15
    v_exp_f32 v3, v3
    v_mul_f32 v2, v2, v14
    v_mul_f32 v3, v3, v14
    v_cvt_pk_bf16_f32 v2, v2, v2
    v_cvt_pk_bf16_f32 v3, v3, v3
    v_and_b32 v10, v20, v2
    v_and_b32 v11, v21, v2
    v_and_b32 v12, v22, v2
    v_and_b32 v13, v23, v2
    s_waitcnt vmcnt(11)
    s_nop 0
    v_mfma_f32_16x16x32_bf16 v[24:27], v[10:13], v[92:95], v[24:27]
    global_load_dwordx4 v[92:95], v6, s[32:33]
    v_and_b32 v10, v20, v3
    v_and_b32 v11, v21, v3
    v_and_b32 v12, v22, v3
    v_and_b32 v13, v23, v3
    s_waitcnt vmcnt(11)
    s_nop 0
    v_mfma_f32_16x16x32_bf16 v[24:27], v[10:13], v[96:99], v[24:27]
    global_load_dwordx4 v[96:99], v7, s[32:33]
    v_lshlrev_b32 v2, 16, v59
    v_fma_f32 v2, v2, s76, v15
    v_exp_f32 v2, v2
    v_and_b32 v3, 0xffff0000, v59
    v_fma_f32 v3, v3, s76, v15
    v_exp_f32 v3, v3
    v_mul_f32 v2, v2, v14
    v_mul_f32 v3, v3, v14
    v_cvt_pk_bf16_f32 v2, v2, v2
    v_cvt_pk_bf16_f32 v3, v3, v3
    v_and_b32 v10, v20, v2
    v_and_b32 v11, v21, v2
    v_and_b32 v12, v22, v2
    v_and_b32 v13, v23, v2
    s_waitcnt vmcnt(11)
    s_nop 0
    v_mfma_f32_16x16x32_bf16 v[24:27], v[10:13], v[100:103], v[24:27]
    global_load_dwordx4 v[100:103], v5, s[32:33]
    v_and_b32 v10, v20, v3
    v_and_b32 v11, v21, v3
    v_and_b32 v12, v22, v3
    v_and_b32 v13, v23, v3
    s_waitcnt vmcnt(11)
    s_nop 0
    v_mfma_f32_16x16x32_bf16 v[24:27], v[10:13], v[104:107], v[24:27]
    s_nop 7
    s_nop 1
    v_lshlrev_b32 v2, 4, v125
    v_lshl_add_u32 v2, v124, 5, v2
    s_lshl_b32 s15, s12, 9
    v_add_u32 v2, s15, v2
    v_cmp_gt_u32 vcc, 32, v1
    s_and_saveexec_b64 s[84:85], vcc
    ds_write_b128 v2, v[24:27] offset:3072
    s_mov_b64 exec, s[84:85]
    s_waitcnt lgkmcnt(0)
    s_barrier
    v_and_b32 v2, 7, v1
    v_lshlrev_b32 v2, 2, v2
    s_lshl_b32 s15, s12, 5
    v_add_u32 v2, s15, v2
    ds_read_b32 v28, v2 offset:3072
    ds_read_b32 v29, v2 offset:3584
    ds_read_b32 v30, v2 offset:4096
    ds_read_b32 v31, v2 offset:4608
    ds_read_b32 v32, v2 offset:5120
    ds_read_b32 v33, v2 offset:5632
    ds_read_b32 v34, v2 offset:6144
    ds_read_b32 v35, v2 offset:6656
    ds_read_b32 v36, v2 offset:7168
    ds_read_b32 v37, v2 offset:7680
    ds_read_b32 v38, v2 offset:8192
    ds_read_b32 v39, v2 offset:8704
    ds_read_b32 v40, v2 offset:9216
    ds_read_b32 v41, v2 offset:9728
    ds_read_b32 v42, v2 offset:10240
    ds_read_b32 v43, v2 offset:10752
    s_add_u32 s15, s12, s77
    s_lshl_b32 s15, s15, 2
    v_mov_b32 v3, s15
    ds_read_b32 v44, v3 offset:2304
    ds_read_b32 v45, v3 offset:2368
    ds_read_b32 v46, v3 offset:2432
    s_waitcnt lgkmcnt(0)
    v_mov_b32 v3, v28
    v_add_f32 v3, v3, v29
    v_add_f32 v3, v3, v30
    v_add_f32 v3, v3, v31
    v_add_f32 v3, v3, v32
    v_add_f32 v3, v3, v33
    v_add_f32 v3, v3, v34
    v_add_f32 v3, v3, v35
    v_add_f32 v3, v3, v36
    v_add_f32 v3, v3, v37
    v_add_f32 v3, v3, v38
    v_add_f32 v3, v3, v39
    v_add_f32 v3, v3, v40
    v_add_f32 v3, v3, v41
    v_add_f32 v3, v3, v42
    v_add_f32 v3, v3, v43
    v_cvt_pk_bf16_f32 v3, v3, v3
    v_and_b32 v3, 0xffff0000, v3
    s_nop 1
    v_readlane_b32 s40, v3, 0
    v_readlane_b32 s41, v3, 1
    v_readlane_b32 s42, v3, 2
    v_readlane_b32 s43, v3, 3
    v_readlane_b32 s44, v3, 4
    v_readlane_b32 s45, v3, 5
    v_readlane_b32 s46, v3, 6
    v_readlane_b32 s47, v3, 7
    v_readfirstlane_b32 s48, v44
    v_readfirstlane_b32 s49, v45
    v_readfirstlane_b32 s50, v46
    s_cmp_ge_u32 s12, 11
    s_cselect_b32 s50, 0, s50
    s_waitcnt vmcnt(10)
    v_lshlrev_b32 v6, 16, v108
    v_and_b32 v7, 0xffff0000, v108
    v_mul_f32 v60, s40, v6
    v_mul_f32 v61, s40, v7
    v_lshlrev_b32 v6, 16, v109
    v_and_b32 v7, 0xffff0000, v109
    v_mul_f32 v62, s40, v6
    v_mul_f32 v63, s40, v7
    v_lshlrev_b32 v6, 16, v110
    v_and_b32 v7, 0xffff0000, v110
    v_mul_f32 v64, s40, v6
    v_mul_f32 v65, s40, v7
    v_lshlrev_b32 v6, 16, v111
    v_and_b32 v7, 0xffff0000, v111
    v_mul_f32 v66, s40, v6
    v_mul_f32 v67, s40, v7
    s_waitcnt vmcnt(9)
    v_lshlrev_b32 v6, 16, v112
    v_and_b32 v7, 0xffff0000, v112
    v_fmac_f32 v60, s41, v6
    v_fmac_f32 v61, s41, v7
    v_lshlrev_b32 v6, 16, v113
    v_and_b32 v7, 0xffff0000, v113
    v_fmac_f32 v62, s41, v6
    v_fmac_f32 v63, s41, v7
    v_lshlrev_b32 v6, 16, v114
    v_and_b32 v7, 0xffff0000, v114
    v_fmac_f32 v64, s41, v6
    v_fmac_f32 v65, s41, v7
    v_lshlrev_b32 v6, 16, v115
    v_and_b32 v7, 0xffff0000, v115
    v_fmac_f32 v66, s41, v6
    v_fmac_f32 v67, s41, v7
    s_waitcnt vmcnt(8)
    v_lshlrev_b32 v6, 16, v116
    v_and_b32 v7, 0xffff0000, v116
    v_fmac_f32 v60, s42, v6
    v_fmac_f32 v61, s42, v7
    v_lshlrev_b32 v6, 16, v117
    v_and_b32 v7, 0xffff0000, v117
    v_fmac_f32 v62, s42, v6
    v_fmac_f32 v63, s42, v7
    v_lshlrev_b32 v6, 16, v118
    v_and_b32 v7, 0xffff0000, v118
    v_fmac_f32 v64, s42, v6
    v_fmac_f32 v65, s42, v7
    v_lshlrev_b32 v6, 16, v119
    v_and_b32 v7, 0xffff0000, v119
    v_fmac_f32 v66, s42, v6
    v_fmac_f32 v67, s42, v7
    s_waitcnt vmcnt(7)
    v_lshlrev_b32 v6, 16, v120
    v_and_b32 v7, 0xffff0000, v120
    v_fmac_f32 v60, s43, v6
    v_fmac_f32 v61, s43, v7
    v_lshlrev_b32 v6, 16, v121
    v_and_b32 v7, 0xffff0000, v121
    v_fmac_f32 v62, s43, v6
    v_fmac_f32 v63, s43, v7
    v_lshlrev_b32 v6, 16, v122
    v_and_b32 v7, 0xffff0000, v122
    v_fmac_f32 v64, s43, v6
    v_fmac_f32 v65, s43, v7
    v_lshlrev_b32 v6, 16, v123
    v_and_b32 v7, 0xffff0000, v123
    v_fmac_f32 v66, s43, v6
    v_fmac_f32 v67, s43, v7
    s_waitcnt vmcnt(6)
    v_lshlrev_b32 v6, 16, v76
    v_and_b32 v7, 0xffff0000, v76
    v_fmac_f32 v60, s44, v6
    v_fmac_f32 v61, s44, v7
    v_lshlrev_b32 v6, 16, v77
    v_and_b32 v7, 0xffff0000, v77
    v_fmac_f32 v62, s44, v6
    v_fmac_f32 v63, s44, v7
    v_lshlrev_b32 v6, 16, v78
    v_and_b32 v7, 0xffff0000, v78
    v_fmac_f32 v64, s44, v6
    v_fmac_f32 v65, s44, v7
    v_lshlrev_b32 v6, 16, v79
    v_and_b32 v7, 0xffff0000, v79
    v_fmac_f32 v66, s44, v6
    v_fmac_f32 v67, s44, v7
    s_waitcnt vmcnt(5)
    v_lshlrev_b32 v6, 16, v80
    v_and_b32 v7, 0xffff0000, v80
    v_fmac_f32 v60, s45, v6
    v_fmac_f32 v61, s45, v7
    v_lshlrev_b32 v6, 16, v81
    v_and_b32 v7, 0xffff0000, v81
    v_fmac_f32 v62, s45, v6
    v_fmac_f32 v63, s45, v7
    v_lshlrev_b32 v6, 16, v82
    v_and_b32 v7, 0xffff0000, v82
    v_fmac_f32 v64, s45, v6
    v_fmac_f32 v65, s45, v7
    v_lshlrev_b32 v6, 16, v83
    v_and_b32 v7, 0xffff0000, v83
    v_fmac_f32 v66, s45, v6
    v_fmac_f32 v67, s45, v7
    s_waitcnt vmcnt(4)
    v_lshlrev_b32 v6, 16, v84
    v_and_b32 v7, 0xffff0000, v84
    v_fmac_f32 v60, s46, v6
    v_fmac_f32 v61, s46, v7
    v_lshlrev_b32 v6, 16, v85
    v_and_b32 v7, 0xffff0000, v85
    v_fmac_f32 v62, s46, v6
    v_fmac_f32 v63, s46, v7
    v_lshlrev_b32 v6, 16, v86
    v_and_b32 v7, 0xffff0000, v86
    v_fmac_f32 v64, s46, v6
    v_fmac_f32 v65, s46, v7
    v_lshlrev_b32 v6, 16, v87
    v_and_b32 v7, 0xffff0000, v87
    v_fmac_f32 v66, s46, v6
    v_fmac_f32 v67, s46, v7
    s_waitcnt vmcnt(3)
    v_lshlrev_b32 v6, 16, v88
    v_and_b32 v7, 0xffff0000, v88
    v_fmac_f32 v60, s47, v6
    v_fmac_f32 v61, s47, v7
    v_lshlrev_b32 v6, 16, v89
    v_and_b32 v7, 0xffff0000, v89
    v_fmac_f32 v62, s47, v6
    v_fmac_f32 v63, s47, v7
    v_lshlrev_b32 v6, 16, v90
    v_and_b32 v7, 0xffff0000, v90
    v_fmac_f32 v64, s47, v6
    v_fmac_f32 v65, s47, v7
    v_lshlrev_b32 v6, 16, v91
    v_and_b32 v7, 0xffff0000, v91
    v_fmac_f32 v66, s47, v6
    v_fmac_f32 v67, s47, v7
    s_waitcnt vmcnt(2)
    v_lshlrev_b32 v6, 16, v92
    v_and_b32 v7, 0xffff0000, v92
    v_mul_f32 v68, s48, v6
    v_mul_f32 v69, s48, v7
    v_lshlrev_b32 v6, 16, v93
    v_and_b32 v7, 0xffff0000, v93
    v_mul_f32 v70, s48, v6
    v_mul_f32 v71, s48, v7
    v_lshlrev_b32 v6, 16, v94
    v_and_b32 v7, 0xffff0000, v94
    v_mul_f32 v72, s48, v6
    v_mul_f32 v73, s48, v7
    v_lshlrev_b32 v6, 16, v95
    v_and_b32 v7, 0xffff0000, v95
    v_mul_f32 v74, s48, v6
    v_mul_f32 v75, s48, v7
    s_waitcnt vmcnt(1)
    v_lshlrev_b32 v6, 16, v96
    v_and_b32 v7, 0xffff0000, v96
    v_fmac_f32 v68, s49, v6
    v_fmac_f32 v69, s49, v7
    v_lshlrev_b32 v6, 16, v97
    v_and_b32 v7, 0xffff0000, v97
    v_fmac_f32 v70, s49, v6
    v_fmac_f32 v71, s49, v7
    v_lshlrev_b32 v6, 16, v98
    v_and_b32 v7, 0xffff0000, v98
    v_fmac_f32 v72, s49, v6
    v_fmac_f32 v73, s49, v7
    v_lshlrev_b32 v6, 16, v99
    v_and_b32 v7, 0xffff0000, v99
    v_fmac_f32 v74, s49, v6
    v_fmac_f32 v75, s49, v7
    s_waitcnt vmcnt(0)
    v_lshlrev_b32 v6, 16, v100
    v_and_b32 v7, 0xffff0000, v100
    v_fmac_f32 v68, s50, v6
    v_fmac_f32 v69, s50, v7
    v_lshlrev_b32 v6, 16, v101
    v_and_b32 v7, 0xffff0000, v101
    v_fmac_f32 v70, s50, v6
    v_fmac_f32 v71, s50, v7
    v_lshlrev_b32 v6, 16, v102
    v_and_b32 v7, 0xffff0000, v102
    v_fmac_f32 v72, s50, v6
    v_fmac_f32 v73, s50, v7
    v_lshlrev_b32 v6, 16, v103
    v_and_b32 v7, 0xffff0000, v103
    v_fmac_f32 v74, s50, v6
    v_fmac_f32 v75, s50, v7
    s_lshl_b32 s15, s12, 12
    v_lshlrev_b32 v2, 5, v1
    v_add_u32 v2, s15, v2
    v_add_u32 v2, 52224, v2
    ds_write_b128 v2, v[60:63] offset:0
    ds_write_b128 v2, v[64:67] offset:16
    ds_write_b128 v2, v[68:71] offset:2048
    ds_write_b128 v2, v[72:75] offset:2064
    s_waitcnt lgkmcnt(0)
    s_barrier
    v_lshlrev_b32 v2, 2, v0
    v_add_u32 v4, 52224, v2
    ds_read_b32 v28, v4 offset:0
    ds_read_b32 v29, v4 offset:4096
    ds_read_b32 v30, v4 offset:8192
    ds_read_b32 v31, v4 offset:12288
    ds_read_b32 v32, v4 offset:16384
    ds_read_b32 v33, v4 offset:20480
    ds_read_b32 v34, v4 offset:24576
    ds_read_b32 v35, v4 offset:28672
    ds_read_b32 v36, v4 offset:32768
    ds_read_b32 v37, v4 offset:36864
    ds_read_b32 v38, v4 offset:40960
    ds_read_b32 v39, v4 offset:45056
    ds_read_b32 v40, v4 offset:49152
    ds_read_b32 v41, v4 offset:53248
    ds_read_b32 v42, v4 offset:57344
    ds_read_b32 v43, v4 offset:61440
    s_waitcnt lgkmcnt(0)
    v_mov_b32 v3, v28
    v_add_f32 v3, v3, v29
    v_add_f32 v3, v3, v30
    v_add_f32 v3, v3, v31
    v_add_f32 v3, v3, v32
    v_add_f32 v3, v3, v33
    v_add_f32 v3, v3, v34
    v_add_f32 v3, v3, v35
    v_add_f32 v3, v3, v36
    v_add_f32 v3, v3, v37
    v_add_f32 v3, v3, v38
    v_add_f32 v3, v3, v39
    v_add_f32 v3, v3, v40
    v_add_f32 v3, v3, v41
    v_add_f32 v3, v3, v42
    v_add_f32 v3, v3, v43
    s_lshl_b32 s15, s2, 12
    s_add_u32 s82, s38, s15
    s_addc_u32 s83, s39, 0
    global_store_dword v2, v3, s[82:83] sc0 sc1
    s_waitcnt vmcnt(0)
    s_barrier
    s_cmp_lg_u32 s12, 0
    s_cbranch_scc1 L_cnt_done
    s_lshl_b32 s15, s13, 5
    v_mov_b32 v2, s15
    v_mov_b32 v3, 1
    v_cmp_eq_u32 vcc, 0, v1
    s_and_saveexec_b64 s[84:85], vcc
    global_atomic_add v4, v2, v3, s[36:37] sc0 sc1
    s_waitcnt vmcnt(0)
    v_mov_b32 v2, 0
    ds_write_b32 v2, v4 offset:2688
    s_mov_b64 exec, s[84:85]
    s_waitcnt lgkmcnt(0)
L_cnt_done:
    s_barrier
    v_mov_b32 v2, 0
    ds_read_b32 v3, v2 offset:2688
    s_waitcnt lgkmcnt(0)
    v_readfirstlane_b32 s15, v3
    s_cmp_lg_u32 s15, 31
    s_cbranch_scc1 L_end
    s_lshl_b32 s15, s13, 17
    s_add_u32 s82, s38, s15
    s_addc_u32 s83, s39, 0
    v_lshlrev_b32 v2, 2, v0
    global_load_dword v28, v2, s[82:83] sc0 sc1
    v_add_u32 v2, 0x1000, v2
    global_load_dword v29, v2, s[82:83] sc0 sc1
    v_add_u32 v2, 0x1000, v2
    global_load_dword v30, v2, s[82:83] sc0 sc1
    v_add_u32 v2, 0x1000, v2
    global_load_dword v31, v2, s[82:83] sc0 sc1
    v_add_u32 v2, 0x1000, v2
    global_load_dword v32, v2, s[82:83] sc0 sc1
    v_add_u32 v2, 0x1000, v2
    global_load_dword v33, v2, s[82:83] sc0 sc1
    v_add_u32 v2, 0x1000, v2
    global_load_dword v34, v2, s[82:83] sc0 sc1
    v_add_u32 v2, 0x1000, v2
    global_load_dword v35, v2, s[82:83] sc0 sc1
    v_add_u32 v2, 0x1000, v2
    global_load_dword v36, v2, s[82:83] sc0 sc1
    v_add_u32 v2, 0x1000, v2
    global_load_dword v37, v2, s[82:83] sc0 sc1
    v_add_u32 v2, 0x1000, v2
    global_load_dword v38, v2, s[82:83] sc0 sc1
    v_add_u32 v2, 0x1000, v2
    global_load_dword v39, v2, s[82:83] sc0 sc1
    v_add_u32 v2, 0x1000, v2
    global_load_dword v40, v2, s[82:83] sc0 sc1
    v_add_u32 v2, 0x1000, v2
    global_load_dword v41, v2, s[82:83] sc0 sc1
    v_add_u32 v2, 0x1000, v2
    global_load_dword v42, v2, s[82:83] sc0 sc1
    v_add_u32 v2, 0x1000, v2
    global_load_dword v43, v2, s[82:83] sc0 sc1
    v_add_u32 v2, 0x1000, v2
    global_load_dword v44, v2, s[82:83] sc0 sc1
    v_add_u32 v2, 0x1000, v2
    global_load_dword v45, v2, s[82:83] sc0 sc1
    v_add_u32 v2, 0x1000, v2
    global_load_dword v46, v2, s[82:83] sc0 sc1
    v_add_u32 v2, 0x1000, v2
    global_load_dword v47, v2, s[82:83] sc0 sc1
    v_add_u32 v2, 0x1000, v2
    global_load_dword v48, v2, s[82:83] sc0 sc1
    v_add_u32 v2, 0x1000, v2
    global_load_dword v49, v2, s[82:83] sc0 sc1
    v_add_u32 v2, 0x1000, v2
    global_load_dword v50, v2, s[82:83] sc0 sc1
    v_add_u32 v2, 0x1000, v2
    global_load_dword v51, v2, s[82:83] sc0 sc1
    v_add_u32 v2, 0x1000, v2
    global_load_dword v52, v2, s[82:83] sc0 sc1
    v_add_u32 v2, 0x1000, v2
    global_load_dword v53, v2, s[82:83] sc0 sc1
    v_add_u32 v2, 0x1000, v2
    global_load_dword v54, v2, s[82:83] sc0 sc1
    v_add_u32 v2, 0x1000, v2
    global_load_dword v55, v2, s[82:83] sc0 sc1
    v_add_u32 v2, 0x1000, v2
    global_load_dword v56, v2, s[82:83] sc0 sc1
    v_add_u32 v2, 0x1000, v2
    global_load_dword v57, v2, s[82:83] sc0 sc1
    v_add_u32 v2, 0x1000, v2
    global_load_dword v58, v2, s[82:83] sc0 sc1
    v_add_u32 v2, 0x1000, v2
    global_load_dword v59, v2, s[82:83] sc0 sc1
    v_and_b32 v4, 511, v0
    v_lshlrev_b32 v4, 1, v4
    s_lshl_b32 s15, s13, 10
    v_add_u32 v4, s15, v4
    global_load_ushort v5, v4, s[16:17]
    s_waitcnt vmcnt(0)
    v_mov_b32 v3, v28
    v_add_f32 v3, v3, v29
    v_add_f32 v3, v3, v30
    v_add_f32 v3, v3, v31
    v_add_f32 v3, v3, v32
    v_add_f32 v3, v3, v33
    v_add_f32 v3, v3, v34
    v_add_f32 v3, v3, v35
    v_add_f32 v3, v3, v36
    v_add_f32 v3, v3, v37
    v_add_f32 v3, v3, v38
    v_add_f32 v3, v3, v39
    v_add_f32 v3, v3, v40
    v_add_f32 v3, v3, v41
    v_add_f32 v3, v3, v42
    v_add_f32 v3, v3, v43
    v_add_f32 v3, v3, v44
    v_add_f32 v3, v3, v45
    v_add_f32 v3, v3, v46
    v_add_f32 v3, v3, v47
    v_add_f32 v3, v3, v48
    v_add_f32 v3, v3, v49
    v_add_f32 v3, v3, v50
    v_add_f32 v3, v3, v51
    v_add_f32 v3, v3, v52
    v_add_f32 v3, v3, v53
    v_add_f32 v3, v3, v54
    v_add_f32 v3, v3, v55
    v_add_f32 v3, v3, v56
    v_add_f32 v3, v3, v57
    v_add_f32 v3, v3, v58
    v_add_f32 v3, v3, v59
    v_cvt_pk_bf16_f32 v3, v3, v3
    v_and_b32 v3, 0xffff0000, v3
    v_and_b32 v2, 511, v0
    v_lshlrev_b32 v2, 2, v2
    v_add_u32 v2, 117760, v2
    s_cmp_lt_u32 s12, 8
    s_cbranch_scc1 L_fa
    ds_write_b32 v2, v3
    s_waitcnt lgkmcnt(0)
L_fa:
    s_barrier
    s_cmp_ge_u32 s12, 8
    s_cbranch_scc1 L_end
    ds_read_b32 v6, v2
    v_lshlrev_b32 v5, 16, v5
    v_add_f32 v3, v5, v3
    v_cvt_pk_bf16_f32 v3, v3, v3
    v_and_b32 v3, 0xffff0000, v3
    s_waitcnt lgkmcnt(0)
    v_add_f32 v3, v3, v6
    v_cvt_pk_bf16_f32 v3, v3, v3
    global_store_short v4, v3, s[34:35]
L_end:
    s_endpgm
.section .rodata,"a"
.p2align 6
.amdhsa_kernel parallel_sum__gqa_block_cached__glu_gated_reglu__decode_kernel
  .amdhsa_next_free_vgpr 128
  .amdhsa_next_free_sgpr 96
  .amdhsa_accum_offset 128
  .amdhsa_group_segment_fixed_size 0
  .amdhsa_kernarg_size 96
  .amdhsa_user_sgpr_count 2
  .amdhsa_user_sgpr_kernarg_segment_ptr 1
  .amdhsa_system_sgpr_workgroup_id_x 1
.end_amdhsa_kernel
```
